```python
import torch

def _softmax(x, axis=-1):
    return torch.softmax(x, dim=axis)
def _gelu(x):
    return torch.nn.functional.gelu(x, approximate="tanh")
def _silu(x):
    return torch.nn.functional.silu(x)
def _sigmoid(x):
    return torch.sigmoid(x)
def _layernorm(x, axis=-1, eps=1e-5):
    m = x.mean(dim=axis, keepdim=True)
    v = x.var(dim=axis, keepdim=True, unbiased=False)
    return (x - m) / torch.sqrt(v + eps)
def _scatter_add(tgt, idx, src, axis=0):
    return tgt.clone().index_add_(axis, idx, src)
def _segment_sum(src, seg, n):
    out = torch.zeros((n,) + src.shape[1:], dtype=src.dtype)
    return out.index_add_(0, seg, src)
def _pad(x, pw):
    flat = tuple(v for pair in reversed(pw) for v in pair)
    return torch.nn.functional.pad(x, flat)

kernel_name = 'interleave_layers__sliding_local_dilated__moe_arch_mod__prompt'

def setup_inputs():

    _w = (lambda a: (lambda t: t.to(torch.bfloat16) if t.is_floating_point() else t)(torch.as_tensor(a)))
    def _A_setup():
        B, S, D = 1, 2048, 512
        return {
            "x": _w((lambda *s: torch.randn(*s, dtype=torch.bfloat16) * 0.05)(B, S, D)),
            "wqkv": _w((lambda *s: torch.randn(*s, dtype=torch.bfloat16) * 0.05)(D, 3 * D)),
            "wo": _w((lambda *s: torch.randn(*s, dtype=torch.bfloat16) * 0.05)(D, D)),
        }
    _A_in = _A_setup()

    def _B_setup():
        B, S, D, F, C = 1, 2048, 512, 1376, 2
        return {
            "x": _w((lambda *s: torch.randn(*s, dtype=torch.bfloat16) * 0.05)(B, S, D)),
            "w_r": _w((lambda *s: torch.randn(*s, dtype=torch.bfloat16) * 0.05)(D)),
            "w_gate": _w((lambda *s: torch.randn(*s, dtype=torch.bfloat16) * 0.05)(D, F)),
            "w_up": _w((lambda *s: torch.randn(*s, dtype=torch.bfloat16) * 0.05)(D, F)),
            "w_down": _w((lambda *s: torch.randn(*s, dtype=torch.bfloat16) * 0.05)(F, D)),
        }
    _B_in = _B_setup()

    return {
        "A_x": _A_in["x"],
        "A_wqkv": _A_in["wqkv"],
        "A_wo": _A_in["wo"],
        "B_x": _B_in["x"],
        "B_w_r": _B_in["w_r"],
        "B_w_gate": _B_in["w_gate"],
        "B_w_up": _B_in["w_up"],
        "B_w_down": _B_in["w_down"],
    }

def reference(A_x, A_wqkv, A_wo, B_x, B_w_r, B_w_gate, B_w_up, B_w_down):
    def _A_ref(x, wqkv, wo):
        B, S, D = x.shape
        H = 32; Dh = D // H
        W, dil = 8, 2
        qkv = (lambda x, *d: x.permute(*d))((x @ wqkv).reshape(B, S, 3, H, Dh), 2, 0, 3, 1, 4)
        q, k, v = qkv[0], qkv[1], qkv[2]
        scale = Dh ** -0.5
        pos = torch.arange(S)
        off = torch.arange(W) * dil
        idx = pos[:, None] - off[None, :]
        mask = idx >= 0
        idx_c = torch.where(mask, idx, 0).reshape(-1)
        kg = k[:, :, idx_c, :].reshape(B, H, S, W, Dh)
        vg = v[:, :, idx_c, :].reshape(B, H, S, W, Dh)
        logits = torch.einsum("bhsd,bhswd->bhsw", q, kg) * scale
        logits = torch.where(mask[None, None, :, :], logits, -1e9)
        attn = _softmax(logits, axis=-1)
        o = torch.einsum("bhsw,bhswd->bhsd", attn, vg)
        return (lambda x, *d: x.permute(*d))(o, 0, 2, 1, 3).reshape(B, S, D) @ wo

    def _B_ref(x, w_r, w_gate, w_up, w_down):
        B, S, D = x.shape
        C = 2
        r = x @ w_r
        idx = torch.argsort(-r, axis=-1)[:, :C]
        idx_e = (lambda x, n, axis: torch.repeat_interleave(x, n, dim=axis))(idx.reshape(B, C, 1), D, axis=2)
        x_sel = (lambda x, i, axis: torch.take_along_dim(x, i, dim=axis))(x, idx_e, axis=1)
        g = _silu(x_sel @ w_gate)
        u = x_sel @ w_up
        y = (g * u) @ w_down
        r_sel = _sigmoid((lambda x, i, axis: torch.take_along_dim(x, i, dim=axis))(r, idx, axis=1))
        y = y * r_sel.reshape(B, C, 1)
        b_off = (torch.arange(B) * S).reshape(B, 1)
        flat_idx = (idx + b_off).reshape(B * C)
        zero = (x * 0.0).reshape(B * S, D)
        upd = _scatter_add(zero, flat_idx, y.reshape(B * C, D), axis=0)
        return x + upd.reshape(B, S, D)

    x = A_x
    x = x + _A_ref(_layernorm(x, axis=-1), A_wqkv, A_wo)
    x = x + _B_ref(_layernorm(x, axis=-1), B_w_r, B_w_gate, B_w_up, B_w_down)
    x = x + _A_ref(_layernorm(x, axis=-1), A_wqkv, A_wo)
    x = x + _B_ref(_layernorm(x, axis=-1), B_w_r, B_w_gate, B_w_up, B_w_down)
    return x
```

```asm
; @launch grid=(256,1,1) block=(256,1,1) lds=163840
.amdgcn_target "amdgcn-amd-amdhsa--gfx950"
.text
.globl interleave_layers__sliding_local_dilated__moe_arch_mod__prompt_kernel
.p2align 8
.type interleave_layers__sliding_local_dilated__moe_arch_mod__prompt_kernel,@function
interleave_layers__sliding_local_dilated__moe_arch_mod__prompt_kernel:
    s_cmp_ge_u32 s2, 256
    s_cbranch_scc1 L_end
    s_load_dwordx2 s[8:9], s[0:1], 8
    s_load_dwordx2 s[4:5], s[0:1], 0
    v_lshrrev_b32 v6, 6, v0
    v_lshrrev_b32 v7, 3, v0
    v_readfirstlane_b32 s50, v6
    v_and_b32 v8, 2, v7
    v_and_b32 v6, 1, v6
    v_lshl_or_b32 v8, v6, 2, v8
    v_and_b32 v9, 7, v0
    v_xor_b32 v8, v8, v9
    s_bfe_u32 s53, s2, 0x30003
    s_lshl_b32 s60, s53, 7
    v_lshl_add_u32 v8, v8, 4, s60
    v_mul_u32_u24 v94, 3072, v7
    v_add_u32 v94, v94, v8
    s_mul_i32 s88, s50, 3072
    s_add_u32 s88, s88, 75776
    s_mov_b32 s10, 1572864
    s_mov_b32 s11, 0x20000
    s_mov_b32 s6, 2097152
    s_mov_b32 s7, 0x20000
    v_lshl_add_u32 v92, v7, 10, v8
    v_bfe_u32 v4, v0, 4, 2
    v_and_b32 v93, 7, v7
    v_xor_b32 v8, v9, v4
    v_lshlrev_b32 v8, 4, v8
    v_lshl_add_u32 v11, v93, 11, v8
    v_xor_b32 v12, 64, v11
    v_add_u32 v12, 16384, v12
    s_and_b32 s51, s2, 7
    s_lshr_b32 s60, s2, 6
    s_lshl_b32 s54, s51, 2
    s_add_u32 s54, s54, s60
    s_and_b32 s56, s54, 15
    s_lshl_b32 s64, s56, 17
    s_and_b32 s61, s54, 16
    s_lshl_b32 s61, s61, 6
    s_add_u32 s64, s64, s61
    s_lshl_b32 s86, s50, 15
    s_add_u32 s86, s86, s64
    s_lshl_b32 s87, s50, 11
    s_mov_b32 s59, 0
    s_waitcnt lgkmcnt(0)
    s_add_u32 m0, s87, 0
    s_add_u32 s63, s86, 0
    buffer_load_dwordx4 v11, s[4:7], s63 offen nt lds
    s_add_u32 m0, s88, 24576
    s_mov_b32 s63, 0
    buffer_load_dwordx4 v94, s[8:11], s63 offen offset:0 lds
    s_load_dwordx16 s[28:43], s[0:1], 0
    s_load_dwordx4 s[44:47], s[0:1], 64
    s_load_dwordx2 s[48:49], s[0:1], 80
    v_and_b32 v2, 63, v0
    v_and_b32 v3, 15, v0
    v_lshlrev_b32 v5, 4, v2
    s_lshr_b32 s52, s2, 3
    s_lshr_b32 s55, s54, 4
    buffer_load_dwordx4 v94, s[8:11], s63 offen offset:1024 lds
    s_lshl_b32 s62, s53, 2
    s_add_u32 s62, s62, s50
    s_lshl_b32 s62, s62, 12
    s_add_u32 s62, s62, s64
    v_lshrrev_b32 v6, 5, v2
    buffer_load_dwordx4 v94, s[8:11], s63 offen offset:2048 lds
    v_and_b32 v7, 31, v2
    v_lshlrev_b32 v7, 4, v7
    v_lshl_add_u32 v95, v6, 11, v7
    s_min_u32 s65, s56, 1
    s_xor_b32 s57, s65, 1
    s_add_u32 m0, s87, 1024
    s_add_u32 s63, s86, 0
    buffer_load_dwordx4 v12, s[4:7], s63 offen nt lds
    s_lshl_b32 s65, s65, 15
    s_sub_u32 s65, s64, s65
    s_lshl_b32 s61, s50, 7
    s_add_u32 s65, s65, s61
    s_mul_i32 s64, s50, 1280
    s_add_u32 m0, s88, 36864
    s_mov_b32 s63, 98304
    buffer_load_dwordx4 v94, s[8:11], s63 offen offset:0 lds
    s_lshl_b32 s56, s56, 6
    s_lshl_b32 s60, s2, 2
    s_add_u32 s60, s60, s50
    s_mul_i32 s61, s60, 1536
    s_lshl_b32 s60, s60, 9
    buffer_load_dwordx4 v94, s[8:11], s63 offen offset:1024 lds
    v_lshl_add_u32 v96, v2, 7, s61
    v_lshl_add_u32 v97, v2, 7, s60
    s_lshl_b32 s94, s52, 2
    s_add_u32 s94, s94, s50
    s_lshl_b32 s60, s94, 10
    buffer_load_dwordx4 v94, s[8:11], s63 offen offset:2048 lds
    v_lshl_add_u32 v9, v3, 17, s60
    v_cmp_lt_u32 vcc, 15, v2
    s_add_u32 m0, s64, 65536
    s_nop 0
    buffer_load_dwordx4 v12, s[4:7], s65 offen nt lds
    s_sub_u32 s60, 384, s8
    s_and_b32 s60, s60, 0x380
    v_add_u32 v6, s60, v9
    v_cndmask_b32 v96, v96, v6, vcc
    s_getpc_b64 s[60:61]
L_pc:
    s_lshl_b32 s94, s94, 8
    v_lshl_add_u32 v6, v2, 7, s94
    v_min_u32 v6, L_end-L_pc, v6
    s_mov_b64 exec, 3
    global_load_dword v10, v6, s[60:61]
    s_mov_b64 exec, 0x0fff0fff
    buffer_load_dword v10, v96, s[8:11], 0 offen
    s_mov_b64 exec, -1
    buffer_load_dwordx4 v[124:127], v95, s[4:7], s62 offen nt
    buffer_load_dwordx4 v[128:131], v95, s[4:7], s62 offen offset:512 nt
    s_waitcnt lgkmcnt(0)
    s_add_u32 s60, s48, 6717440
    s_addc_u32 s61, s49, 0
    s_load_dword s76, s[60:61], 0
    s_sub_u32 s60, 384, s32
    s_and_b32 s60, s60, 0x380
    v_add_u32 v6, s60, v9
    v_cndmask_b32 v97, v97, v6, vcc
    s_mov_b32 s97, s62
    s_mov_b32 exec_lo, 0x01010101
    s_mov_b32 exec_hi, 0x01010101
    buffer_load_dword v10, v95, s[4:7], s97 offen sc1
    buffer_load_dword v10, v95, s[4:7], s97 offen offset:512 sc1
    s_mov_b64 exec, -1
    v_mov_b32 v98, s36
    v_mov_b32 v99, s37
    v_lshl_add_u32 v98, v2, 7, v98
    s_add_u32 s60, s48, 2097024
    s_addc_u32 s61, s49, 0
    v_writelane_b32 v98, s60, 8
    v_writelane_b32 v99, s61, 8
    s_add_u32 s60, s48, 4194304
    s_addc_u32 s61, s49, 0
    v_writelane_b32 v98, s60, 9
    v_writelane_b32 v99, s61, 9
    s_lshl_b32 s60, s54, 3
    s_add_u32 s60, s60, s53
    s_lshl_b32 s60, s60, 7
    s_add_u32 s60, s60, 6553728
    s_add_u32 s60, s48, s60
    s_addc_u32 s61, s49, 0
    v_writelane_b32 v98, s60, 10
    v_writelane_b32 v99, s61, 10
    s_add_u32 s60, s48, 10485760
    s_addc_u32 s61, s49, 0
    v_writelane_b32 v98, s60, 11
    v_writelane_b32 v99, s61, 11
    s_add_u32 s60, s48, 12582912
    s_addc_u32 s61, s49, 0
    v_writelane_b32 v98, s60, 12
    v_writelane_b32 v99, s61, 12
    v_writelane_b32 v98, s44, 13
    v_writelane_b32 v99, s45, 13
    v_writelane_b32 v98, s38, 14
    v_writelane_b32 v99, s39, 14
    v_writelane_b32 v98, s40, 15
    v_writelane_b32 v99, s41, 15
    v_writelane_b32 v98, s42, 16
    v_writelane_b32 v99, s43, 16
    s_add_u32 s60, s36, 1024
    s_cselect_b32 s60, 0x1ff00, 0
    s_cselect_b32 s60, s60, 0x1ffff
    s_lshl_b32 s61, 0x11111111, s50
    s_and_b32 exec_lo, s60, s61
    s_mov_b32 exec_hi, 0
    global_load_dword v10, v[98:99], off sc1
    s_mov_b64 exec, 0x000f000f
    global_load_dword v10, v97, s[32:33]
    s_mov_b64 exec, -1
    s_mov_b32 s12, s48
    s_and_b32 s13, s49, 0xffff
    s_mov_b32 s14, 16777216
    s_mov_b32 s15, 0x20000
    s_mov_b32 s16, s44
    s_and_b32 s17, s45, 0xffff
    s_mov_b32 s18, 2097152
    s_mov_b32 s19, 0x20000
    s_cmp_lt_u32 s50, 2
    s_cselect_b64 s[24:25], s[38:39], s[40:41]
    s_and_b32 s25, s25, 0xffff
    s_mov_b32 s26, 1409024
    s_mov_b32 s27, 0x20000
    s_mov_b32 s20, s42
    s_and_b32 s21, s43, 0xffff
    s_mov_b32 s22, 1409024
    s_mov_b32 s23, 0x20000
    s_and_b32 s60, s52, 15
    s_mul_i32 s78, s51, 11
    s_add_u32 s78, s78, s60
    s_cmp_lt_u32 s60, 11
    s_cselect_b32 s79, 1, 0
    s_cmp_lt_u32 s78, 86
    s_cselect_b32 s79, s79, 0
    s_lshl_b32 s60, s52, 1
    s_and_b32 s61, s50, 1
    s_add_u32 s60, s60, s61
    s_mul_i32 s60, s60, 22016
    s_mul_i32 s61, s51, 352
    s_add_u32 s60, s60, s61
    v_add_u32 v6, 0, v2
    v_mul_u32_u24 v7, 171, v6
    v_lshrrev_b32 v7, 12, v7
    v_mul_u32_u24 v7, 2368, v7
    v_lshl_add_u32 v6, v6, 4, s60
    v_add_u32 v96, v6, v7
    v_add_u32 v6, 64, v2
    v_mul_u32_u24 v7, 171, v6
    v_lshrrev_b32 v7, 12, v7
    v_mul_u32_u24 v7, 2368, v7
    v_lshl_add_u32 v6, v6, 4, s60
    v_add_u32 v97, v6, v7
    v_add_u32 v6, 128, v2
    v_mul_u32_u24 v7, 171, v6
    v_lshrrev_b32 v7, 12, v7
    v_mul_u32_u24 v7, 2368, v7
    v_lshl_add_u32 v6, v6, 4, s60
    v_add_u32 v98, v6, v7
    v_bfe_u32 v7, v2, 2, 2
    v_lshl_add_u32 v6, v4, 3, v7
    v_mul_u32_u24 v13, 384, v6
    v_and_b32 v6, 3, v2
    v_lshl_add_u32 v13, v6, 3, v13
    s_lshl_b32 s60, s50, 5
    s_add_u32 s60, s60, 12288
    v_add_u32 v13, s60, v13
    v_lshlrev_b32 v14, 4, v6
    v_lshl_add_u32 v14, v7, 13, v14
    v_and_b32 v6, 1, v4
    v_lshl_add_u32 v14, v6, 8, v14
    v_lshrrev_b32 v6, 1, v4
    v_lshl_add_u32 v14, v6, 6, v14
    s_mul_i32 s60, s51, 12
    s_add_u32 s60, s60, s50
    s_lshl_b32 s60, s60, 15
    s_and_b32 s61, s52, 15
    s_lshl_b32 s61, s61, 9
    s_add_u32 s60, s60, s61
    s_lshr_b32 s61, s52, 4
    s_lshl_b32 s61, s61, 7
    s_add_u32 s60, s60, s61
    s_add_u32 s60, s60, 10485760
    v_add_u32 v14, s60, v14
    s_lshl_b32 s61, s78, 14
    s_cmp_eq_u32 s79, 1
    s_cselect_b32 s61, s61, 0x40000000
    s_lshl_b32 s60, s50, 12
    s_add_u32 s61, s61, s60
    v_add_u32 v93, s61, v5
    v_mov_b32 v16, 0x3f803f80
    v_mov_b32 v17, 0x3f803f80
    v_lshrrev_b32 v6, 5, v0
    v_mul_u32_u24 v6, 1280, v6
    v_and_b32 v7, 31, v0
    v_lshl_add_u32 v6, v7, 2, v6
    v_add_u32 v6, 66560, v6
    ds_write2_b32 v6, v16, v16 offset0:0 offset1:32
    v_lshlrev_b32 v15, 2, v3
    v_add_u32 v15, 153600, v15
    v_lshlrev_b32 v18, 4, v4
    v_add_u32 v18, 153600, v18
    v_mov_b32 v6, 0
    ds_write2_b32 v15, v6, v6 offset0:0 offset1:80
    v_and_b32 v6, 1, v4
    v_lshlrev_b32 v19, 5, v6
    v_lshrrev_b32 v7, 1, v4
    v_lshl_add_u32 v19, v7, 4, v19
    v_lshlrev_b32 v20, 14, v6
    v_lshl_add_u32 v20, v7, 8, v20
    v_lshl_add_u32 v20, v3, 4, v20
    s_lshl_b32 s60, s54, 16
    s_lshl_b32 s61, s53, 11
    s_add_u32 s60, s60, s61
    s_lshl_b32 s61, s50, 9
    s_add_u32 s60, s60, s61
    v_add_u32 v20, s60, v20
    v_lshrrev_b32 v6, 1, v3
    v_xor_b32 v6, v4, v6
    v_lshlrev_b32 v6, 4, v6
    v_lshl_add_u32 v21, v3, 7, v6
    v_and_b32 v7, 1, v3
    v_lshlrev_b32 v7, 7, v7
    v_lshl_add_u32 v7, v4, 4, v7
    v_add_u32 v7, 66560, v7
    v_add_u32 v8, 64512, v21
    v_cmp_lt_u32 vcc, 7, v3
    s_nop 1
    v_cndmask_b32 v23, v7, v8, vcc
    v_xor_b32 v22, 64, v21
    v_xor_b32 v24, 64, v23
    v_bfe_u32 v6, v2, 2, 2
    v_and_b32 v8, 3, v2
    v_lshlrev_b32 v8, 3, v8
    v_lshl_add_u32 v8, v6, 7, v8
    v_lshrrev_b32 v6, 1, v6
    v_and_b32 v7, 1, v4
    v_lshl_or_b32 v6, v7, 1, v6
    v_lshl_add_u32 v8, v6, 5, v8
    v_lshl_add_u32 v25, v4, 10, v8
    v_add_u32 v25, 88064, v25
    v_xor_b32 v26, 32, v25
    v_xor_b32 v27, 64, v25
    v_xor_b32 v28, 96, v25
    s_lshl_b32 s60, s50, 5
    v_xor_b32 v8, s60, v8
    v_mul_u32_u24 v99, 3072, v4
    v_add_u32 v100, v99, v8
    v_add_u32 v99, 75776, v100
    s_lshl_b32 s89, s50, 10
    s_add_u32 s89, s89, 88064
    v_lshlrev_b32 v6, 2, v4
    v_sub_u32 v6, v3, v6
    v_mov_b32 v8, 0xff800000
    s_cmp_eq_u32 s57, 1
    s_cselect_b64 s[66:67], 0, -1
    v_add_u32 v7, 0, v6
    v_cmp_lt_u32 vcc, 7, v7
    s_nop 1
    v_cndmask_b32 v34, 0, v8, vcc
    v_cmp_lt_i32 vcc, -9, v7
    s_nop 1
    v_cndmask_b32 v30, 0, v8, vcc
    v_cndmask_b32 v38, v8, v30, s[66:67]
    v_mov_b32 v9, 0xffff
    v_cndmask_b32 v42, v9, 0, vcc
    v_add_u32 v7, -1, v6
    v_cmp_lt_u32 vcc, 7, v7
    s_nop 1
    v_cndmask_b32 v35, 0, v8, vcc
    v_cmp_lt_i32 vcc, -9, v7
    s_nop 1
    v_cndmask_b32 v31, 0, v8, vcc
    v_cndmask_b32 v39, v8, v31, s[66:67]
    v_mov_b32 v9, 0xffff0000
    v_cndmask_b32 v9, v9, 0, vcc
    v_or_b32 v42, v42, v9
    v_add_u32 v7, -2, v6
    v_cmp_lt_u32 vcc, 7, v7
    s_nop 1
    v_cndmask_b32 v36, 0, v8, vcc
    v_cmp_lt_i32 vcc, -9, v7
    s_nop 1
    v_cndmask_b32 v32, 0, v8, vcc
    v_cndmask_b32 v40, v8, v32, s[66:67]
    v_mov_b32 v9, 0xffff
    v_cndmask_b32 v43, v9, 0, vcc
    v_add_u32 v7, -3, v6
    v_cmp_lt_u32 vcc, 7, v7
    s_nop 1
    v_cndmask_b32 v37, 0, v8, vcc
    v_cmp_lt_i32 vcc, -9, v7
    s_nop 1
    v_cndmask_b32 v33, 0, v8, vcc
    v_cndmask_b32 v41, v8, v33, s[66:67]
    v_mov_b32 v9, 0xffff0000
    v_cndmask_b32 v9, v9, 0, vcc
    v_or_b32 v43, v43, v9
    s_mov_b32 s66, 0xaaaaaaaa
    s_mov_b32 s67, 0xaaaaaaaa
    s_mov_b32 s68, 0xcccccccc
    s_mov_b32 s69, 0xcccccccc
    s_lshl_b32 s60, s54, 10
    s_add_u32 s60, s60, 6553600
    v_lshl_add_u32 v101, v0, 4, s60
    s_lshl_b32 s60, s51, 12
    s_add_u32 s60, s60, 6553728
    v_and_b32 v6, 31, v2
    v_lshl_add_u32 v6, v6, 7, s60
    v_cmp_le_u32 vcc, 128, v0
    s_nop 1
    v_cndmask_b32 v101, v101, v6, vcc
    v_lshlrev_b32 v102, 2, v0
    v_add_u32 v102, 153632, v102
    s_lshl_b32 s60, s2, 2
    s_add_u32 s60, s60, s50
    s_mul_i32 s60, s60, 640
    s_add_u32 s60, s60, 4194304
    v_add_u32 v6, s60, v5
    s_lshl_b32 s92, s54, 2
    s_add_u32 s92, s92, s50
    v_mov_b32 v7, 0x40000000
    v_cmp_gt_u32 vcc, 40, v2
    s_nop 1
    v_cndmask_b32 v103, v7, v6, vcc
    v_cmp_gt_u32 vcc, 16, v2
    v_mov_b32 v108, v7
    s_lshl_b32 s60, s92, 11
    s_lshl_b32 s61, s53, 8
    s_add_u32 s60, s60, s61
    s_add_u32 s61, s60, 5537792
    v_writelane_b32 v108, s61, 16
    s_add_u32 s61, s60, 5537920
    v_writelane_b32 v108, s61, 17
    s_lshl_b32 s60, s54, 9
    s_add_u32 s61, s60, 6619136
    v_writelane_b32 v108, s61, 20
    s_add_u32 s61, s60, 6619264
    v_writelane_b32 v108, s61, 21
    s_add_u32 s61, s60, 6635520
    v_writelane_b32 v108, s61, 22
    s_add_u32 s61, s60, 6635648
    v_writelane_b32 v108, s61, 23
    s_add_u32 s61, s60, 6651904
    v_writelane_b32 v108, s61, 27
    s_add_u32 s61, s60, 6652032
    v_writelane_b32 v108, s61, 28
    s_add_u32 s61, s60, 6652160
    v_writelane_b32 v108, s61, 29
    v_mov_b32 v104, -1
    v_mov_b32 v105, -1
    v_mov_b32 v106, -1
    v_mov_b32 v107, -1
    s_mov_b64 s[70:71], s[32:33]
    s_mov_b64 s[98:99], s[36:37]
    s_lshl_b32 s28, s54, 9
    s_add_u32 s28, s28, 6619136
    s_lshl_b32 s62, s53, 2
    s_add_u32 s62, s62, s50
    s_lshl_b32 s62, s62, 3
    s_add_u32 s29, s62, s28
    v_and_b32 v49, 31, v2
    v_lshlrev_b32 v49, 3, v49
    s_lshl_b32 s60, s92, 14
    v_add_u32 v50, s60, v5
    v_add_u32 v51, 8192, v50
    s_lshl_b32 s61, s53, 7
    s_add_u32 s38, s60, s61
    s_add_u32 s45, s86, s61
    s_lshl_b32 s34, s54, 13
    s_add_u32 s34, s34, s61
    s_add_u32 s34, s34, 4227072
    s_mov_b32 s35, 4227072
    s_lshl_b32 s30, s92, 11
    s_add_u32 s30, s30, 5537792
    s_lshl_b32 s61, s53, 8
    s_add_u32 s31, s30, s61
    s_add_u32 s37, s61, 4489216
    s_lshl_b32 s36, s78, 12
    s_add_u32 s36, s36, 4489216
    s_lshl_b32 s32, s53, 7
    s_add_u32 s32, s32, s92
    s_lshl_b32 s32, s32, 3
    s_add_u32 s32, s32, 4210688
    s_lshl_b32 s33, s51, 10
    s_add_u32 s33, s33, 4210688
    s_add_u32 s39, s28, 32768
    s_lshl_b32 s62, s50, 3
    s_add_u32 s62, s62, s53
    s_lshl_b32 s62, s62, 3
    s_add_u32 s40, s39, s62
    s_and_b32 s62, s52, 15
    s_lshl_b32 s62, s62, 2
    s_add_u32 s62, s62, s50
    s_mul_i32 s61, s51, 48
    s_add_u32 s61, s61, s62
    s_lshl_b32 s43, s61, 13
    s_add_u32 s43, s43, 10485760
    s_lshl_b32 s44, s92, 4
    v_lshl_add_u32 v29, v3, 10, v19
    v_mov_b32 v46, v29
    v_lshlrev_b32 v48, 4, v3
    s_lshl_b32 s62, s50, 9
    s_add_u32 s62, s62, 154240
    v_add_u32 v47, s62, v19
    v_mov_b32 v132, 0
    v_mov_b32 v133, 0
    s_getreg_b32 s77, hwreg(HW_REG_XCC_ID)
    s_and_b32 s77, s77, 15
    s_lshl_b32 s62, s54, 3
    s_add_u32 s62, s62, s53
    s_lshl_b32 s62, s62, 2
    s_add_u32 s62, s62, s50
    s_lshl_b32 s62, s62, 5
    s_add_u32 s62, s62, 6553728
    v_lshrrev_b32 v7, 1, v2
    s_waitcnt vmcnt(8)
    s_add_u32 m0, s87, 8192
    s_add_u32 s63, s86, 128
    buffer_load_dwordx4 v11, s[4:7], s63 offen lds
    s_add_u32 m0, s88, 0
    s_mov_b32 s63, 196608
    buffer_load_dwordx4 v94, s[8:11], s63 offen offset:0 lds
    buffer_load_dwordx4 v94, s[8:11], s63 offen offset:1024 lds
    buffer_load_dwordx4 v94, s[8:11], s63 offen offset:2048 lds
    s_add_u32 m0, s87, 9216
    s_add_u32 s63, s86, 128
    buffer_load_dwordx4 v12, s[4:7], s63 offen lds
    s_add_u32 m0, s88, 12288
    s_mov_b32 s63, 294912
    buffer_load_dwordx4 v94, s[8:11], s63 offen offset:0 lds
    buffer_load_dwordx4 v94, s[8:11], s63 offen offset:1024 lds
    buffer_load_dwordx4 v94, s[8:11], s63 offen offset:2048 lds
    s_waitcnt lgkmcnt(0)
    s_barrier
    ds_read_b64_tr_b16 a[0:1], v99 offset:24576
    ds_read_b64_tr_b16 a[2:3], v99 offset:25088
    ds_read_b128 v[136:139], v23 offset:0
    ds_read_b64_tr_b16 a[4:5], v99 offset:25600
    ds_read_b64_tr_b16 a[6:7], v99 offset:26112
    ds_read_b64_tr_b16 a[8:9], v99 offset:26624
    ds_read_b64_tr_b16 a[10:11], v99 offset:27136
    ds_read_b128 v[140:143], v21 offset:0
    ds_read_b128 v[144:147], v21 offset:2048
    ds_read_b128 v[148:151], v21 offset:4096
    ds_read_b128 v[152:155], v21 offset:6144
    s_waitcnt lgkmcnt(0)
    v_mfma_f32_16x16x32_bf16 v[196:199], a[0:3], v[136:139], 0
    v_mfma_f32_16x16x32_bf16 v[216:219], a[4:7], v[136:139], 0
    ds_read_b64_tr_b16 a[12:13], v99 offset:36864
    s_add_u32 m0, s87, 16384
    s_add_u32 s63, s86, 256
    buffer_load_dwordx4 v11, s[4:7], s63 offen lds
    v_mfma_f32_16x16x32_bf16 v[236:239], v[136:139], a[8:11], 0
    ds_read_b64_tr_b16 a[14:15], v99 offset:37376
    s_add_u32 m0, s88, 49152
    v_mfma_f32_16x16x32_bf16 v[200:203], a[0:3], v[140:143], 0
    ds_read_b128 v[156:159], v24 offset:0
    s_mov_b32 s63, 393216
    buffer_load_dwordx4 v94, s[8:11], s63 offen offset:0 lds
    v_mfma_f32_16x16x32_bf16 v[220:223], a[4:7], v[140:143], 0
    ds_read_b64_tr_b16 a[16:17], v99 offset:37888
    buffer_load_dwordx4 v94, s[8:11], s63 offen offset:1024 lds
    v_mfma_f32_16x16x32_bf16 v[240:243], v[140:143], a[8:11], 0
    ds_read_b64_tr_b16 a[18:19], v99 offset:38400
    v_mfma_f32_16x16x32_bf16 v[204:207], a[0:3], v[144:147], 0
    ds_read_b64_tr_b16 a[20:21], v99 offset:38912
    buffer_load_dwordx4 v94, s[8:11], s63 offen offset:2048 lds
    v_mfma_f32_16x16x32_bf16 v[224:227], a[4:7], v[144:147], 0
    ds_read_b64_tr_b16 a[22:23], v99 offset:39424
    s_add_u32 m0, s87, 17408
    v_mfma_f32_16x16x32_bf16 v[244:247], v[144:147], a[8:11], 0
    ds_read_b128 v[160:163], v22 offset:0
    s_add_u32 s63, s86, 256
    buffer_load_dwordx4 v12, s[4:7], s63 offen lds
    v_mfma_f32_16x16x32_bf16 v[208:211], a[0:3], v[148:151], 0
    ds_read_b128 v[164:167], v22 offset:2048
    s_add_u32 m0, s88, 61440
    s_mov_b32 s63, 491520
    buffer_load_dwordx4 v94, s[8:11], s63 offen offset:0 lds
    v_mfma_f32_16x16x32_bf16 v[228:231], a[4:7], v[148:151], 0
    ds_read_b128 v[168:171], v22 offset:4096
    v_mfma_f32_16x16x32_bf16 v[248:251], v[148:151], a[8:11], 0
    ds_read_b128 v[172:175], v22 offset:6144
    buffer_load_dwordx4 v94, s[8:11], s63 offen offset:1024 lds
    v_mfma_f32_16x16x32_bf16 v[212:215], a[0:3], v[152:155], 0
    buffer_load_dwordx4 v94, s[8:11], s63 offen offset:2048 lds
    v_mfma_f32_16x16x32_bf16 v[232:235], a[4:7], v[152:155], 0
    s_add_u32 m0, s64, 70656
    v_mfma_f32_16x16x32_bf16 v[252:255], v[152:155], a[8:11], 0
    s_add_u32 s65, s65, 512
    buffer_load_dwordx4 v12, s[4:7], s65 offen nt lds
    s_waitcnt lgkmcnt(0)
    s_waitcnt vmcnt(21)
    v_dot2c_f32_bf16 v132, v124, v16
    v_dot2c_f32_bf16 v133, v124, v124
    v_dot2c_f32_bf16 v132, v125, v16
    v_dot2c_f32_bf16 v133, v125, v125
    v_dot2c_f32_bf16 v132, v126, v16
    v_dot2c_f32_bf16 v133, v126, v126
    v_dot2c_f32_bf16 v132, v127, v16
    v_dot2c_f32_bf16 v133, v127, v127
    v_dot2c_f32_bf16 v132, v128, v16
    v_dot2c_f32_bf16 v133, v128, v128
    v_dot2c_f32_bf16 v132, v129, v16
    v_dot2c_f32_bf16 v133, v129, v129
    v_dot2c_f32_bf16 v132, v130, v16
    v_dot2c_f32_bf16 v133, v130, v130
    v_dot2c_f32_bf16 v132, v131, v16
    v_dot2c_f32_bf16 v133, v131, v131
    v_mfma_f32_16x16x32_bf16 v[196:199], a[12:15], v[156:159], v[196:199]
    s_waitcnt vmcnt(9)
    s_barrier
    v_mfma_f32_16x16x32_bf16 v[216:219], a[16:19], v[156:159], v[216:219]
    ds_read_b64_tr_b16 a[24:25], v99 offset:0
    s_add_u32 m0, s87, 24576
    s_mul_i32 s76, s76, 0x9e3779b1
    s_add_u32 s76, s76, 0x7f4a7c15
    v_mfma_f32_16x16x32_bf16 v[236:239], v[156:159], a[20:23], v[236:239]
    ds_read_b64_tr_b16 a[26:27], v99 offset:512
    s_add_u32 s63, s86, 384
    buffer_load_dwordx4 v11, s[4:7], s63 offen lds
    s_mul_i32 s60, s76, 0x85ebca6b
    v_add_f32_dpp v132, v132, v132 row_ror:8 row_mask:0xf bank_mask:0xf
    v_mfma_f32_16x16x32_bf16 v[200:203], a[12:15], v[160:163], v[200:203]
    ds_read_b128 v[136:139], v23 offset:1280
    s_add_u32 m0, s88, 24576
    v_add_f32_dpp v133, v133, v133 row_ror:8 row_mask:0xf bank_mask:0xf
    s_brev_b32 s60, s60
    v_mfma_f32_16x16x32_bf16 v[220:223], a[16:19], v[160:163], v[220:223]
    ds_read_b64_tr_b16 a[28:29], v99 offset:1024
    v_add_f32_dpp v132, v132, v132 row_ror:4 row_mask:0xf bank_mask:0xf
    v_mfma_f32_16x16x32_bf16 v[240:243], v[160:163], a[20:23], v[240:243]
    ds_read_b64_tr_b16 a[30:31], v99 offset:1536
    s_mov_b32 s63, 589824
    v_add_f32_dpp v133, v133, v133 row_ror:4 row_mask:0xf bank_mask:0xf
    v_mfma_f32_16x16x32_bf16 v[204:207], a[12:15], v[164:167], v[204:207]
    ds_read_b64_tr_b16 a[32:33], v99 offset:2048
    buffer_load_dwordx4 v94, s[8:11], s63 offen offset:0 lds
    s_and_b32 s60, s60, 0xfffffff0
    v_mfma_f32_16x16x32_bf16 v[224:227], a[16:19], v[164:167], v[224:227]
    ds_read_b64_tr_b16 a[34:35], v99 offset:2560
    v_add_f32_dpp v132, v132, v132 row_ror:2 row_mask:0xf bank_mask:0xf
    v_mfma_f32_16x16x32_bf16 v[244:247], v[164:167], a[20:23], v[244:247]
    ds_read_b128 v[140:143], v21 offset:8192
    v_add_f32_dpp v133, v133, v133 row_ror:2 row_mask:0xf bank_mask:0xf
    v_mfma_f32_16x16x32_bf16 v[208:211], a[12:15], v[168:171], v[208:211]
    ds_read_b128 v[144:147], v21 offset:10240
    buffer_load_dwordx4 v94, s[8:11], s63 offen offset:1024 lds
    s_or_b32 s77, s77, s60
    v_mfma_f32_16x16x32_bf16 v[228:231], a[16:19], v[168:171], v[228:231]
    ds_read_b128 v[148:151], v21 offset:12288
    v_add_f32_dpp v132, v132, v132 row_ror:1 row_mask:0xf bank_mask:0xf
    v_mfma_f32_16x16x32_bf16 v[248:251], v[168:171], a[20:23], v[248:251]
    ds_read_b128 v[152:155], v21 offset:14336
    v_add_f32_dpp v133, v133, v133 row_ror:1 row_mask:0xf bank_mask:0xf
    v_mfma_f32_16x16x32_bf16 v[212:215], a[12:15], v[172:175], v[212:215]
    v_mov_b32 v134, v132
    v_mfma_f32_16x16x32_bf16 v[232:235], a[16:19], v[172:175], v[232:235]
    buffer_load_dwordx4 v94, s[8:11], s63 offen offset:2048 lds
    v_mov_b32 v135, v133
    v_mfma_f32_16x16x32_bf16 v[252:255], v[172:175], a[20:23], v[252:255]
    v_mov_b32 v112, s76
    s_waitcnt lgkmcnt(0)
    v_mfma_f32_16x16x32_bf16 v[196:199], a[24:27], v[136:139], v[196:199]
    v_mfma_f32_16x16x32_bf16 v[216:219], a[28:31], v[136:139], v[216:219]
    ds_read_b64_tr_b16 a[36:37], v99 offset:12288
    s_add_u32 m0, s87, 25600
    v_permlane16_swap_b32 v132, v134
    v_permlane16_swap_b32 v133, v135
    v_mfma_f32_16x16x32_bf16 v[236:239], v[136:139], a[32:35], v[236:239]
    ds_read_b64_tr_b16 a[38:39], v99 offset:12800
    s_add_u32 s63, s86, 384
    buffer_load_dwordx4 v12, s[4:7], s63 offen lds
    v_add_f32 v132, v132, v134
    v_add_f32 v133, v133, v135
    v_mfma_f32_16x16x32_bf16 v[200:203], a[24:27], v[140:143], v[200:203]
    ds_read_b128 v[156:159], v24 offset:1280
    s_add_u32 m0, s88, 36864
    v_mul_f32 v134, 0x3b000000, v132
    v_mul_f32 v135, 0x3b000000, v133
    v_mfma_f32_16x16x32_bf16 v[220:223], a[28:31], v[140:143], v[220:223]
    ds_read_b64_tr_b16 a[40:41], v99 offset:13312
    v_fma_f32 v135, -v134, v134, v135
    v_mfma_f32_16x16x32_bf16 v[240:243], v[140:143], a[32:35], v[240:243]
    ds_read_b64_tr_b16 a[42:43], v99 offset:13824
    s_mov_b32 s63, 688128
    v_max_f32 v135, 0, v135
    v_mfma_f32_16x16x32_bf16 v[204:207], a[24:27], v[144:147], v[204:207]
    ds_read_b64_tr_b16 a[44:45], v99 offset:14336
    buffer_load_dwordx4 v94, s[8:11], s63 offen offset:0 lds
    v_cvt_pk_bf16_f32 v6, 0, v135
    v_mfma_f32_16x16x32_bf16 v[224:227], a[28:31], v[144:147], v[224:227]
    ds_read_b64_tr_b16 a[46:47], v99 offset:14848
    v_add_f32 v6, 0x3727c5ac, v6
    v_mfma_f32_16x16x32_bf16 v[244:247], v[144:147], a[32:35], v[244:247]
    ds_read_b128 v[160:163], v22 offset:8192
    v_cvt_pk_bf16_f32 v6, 0, v6
    v_mfma_f32_16x16x32_bf16 v[208:211], a[24:27], v[148:151], v[208:211]
    ds_read_b128 v[164:167], v22 offset:10240
    buffer_load_dwordx4 v94, s[8:11], s63 offen offset:1024 lds
    v_sqrt_f32 v6, v6
    v_mfma_f32_16x16x32_bf16 v[228:231], a[28:31], v[148:151], v[228:231]
    ds_read_b128 v[168:171], v22 offset:12288
    v_cvt_pk_bf16_f32 v110, 0, v134
    v_mfma_f32_16x16x32_bf16 v[248:251], v[148:151], a[32:35], v[248:251]
    ds_read_b128 v[172:175], v22 offset:14336
    v_cvt_pk_bf16_f32 v6, 0, v6
    v_mfma_f32_16x16x32_bf16 v[212:215], a[24:27], v[152:155], v[212:215]
    v_rcp_f32 v111, v6
    v_mfma_f32_16x16x32_bf16 v[232:235], a[28:31], v[152:155], v[232:235]
    buffer_load_dwordx4 v94, s[8:11], s63 offen offset:2048 lds
    v_xor_b32 v110, 0x80000000, v110
    v_mfma_f32_16x16x32_bf16 v[252:255], v[152:155], a[32:35], v[252:255]
    v_mov_b32 v113, s77
    s_waitcnt lgkmcnt(0)
    v_mfma_f32_16x16x32_bf16 v[196:199], a[36:39], v[156:159], v[196:199]
    s_waitcnt vmcnt(8)
    s_barrier
    v_mfma_f32_16x16x32_bf16 v[216:219], a[40:43], v[156:159], v[216:219]
    ds_read_b64_tr_b16 a[48:49], v99 offset:49152
    v_mfma_f32_16x16x32_bf16 v[236:239], v[156:159], a[44:47], v[236:239]
    ds_read_b64_tr_b16 a[50:51], v99 offset:49664
    s_mov_b32 exec_lo, 1
    s_mov_b32 exec_hi, 1
    buffer_store_dwordx4 v[110:113], v7, s[12:15], s62 offen sc1
    s_mov_b64 exec, -1
    v_mfma_f32_16x16x32_bf16 v[200:203], a[36:39], v[160:163], v[200:203]
    ds_read_b128 v[136:139], v23 offset:2560
    s_add_u32 m0, s87, 32768
    v_mfma_f32_16x16x32_bf16 v[220:223], a[40:43], v[160:163], v[220:223]
    ds_read_b64_tr_b16 a[52:53], v99 offset:50176
    s_add_u32 s63, s86, 512
    v_mfma_f32_16x16x32_bf16 v[240:243], v[160:163], a[44:47], v[240:243]
    ds_read_b64_tr_b16 a[54:55], v99 offset:50688
    buffer_load_dwordx4 v11, s[4:7], s63 offen lds
    v_mfma_f32_16x16x32_bf16 v[204:207], a[36:39], v[164:167], v[204:207]
    ds_read_b64_tr_b16 a[56:57], v99 offset:51200
    s_add_u32 m0, s88, 0
    v_mfma_f32_16x16x32_bf16 v[224:227], a[40:43], v[164:167], v[224:227]
    ds_read_b64_tr_b16 a[58:59], v99 offset:51712
    s_mov_b32 s63, 786432
    v_mfma_f32_16x16x32_bf16 v[244:247], v[164:167], a[44:47], v[244:247]
    ds_read_b128 v[140:143], v21 offset:16384
    buffer_load_dwordx4 v94, s[8:11], s63 offen offset:0 lds
    v_mfma_f32_16x16x32_bf16 v[208:211], a[36:39], v[168:171], v[208:211]
    ds_read_b128 v[144:147], v21 offset:18432
    v_mfma_f32_16x16x32_bf16 v[228:231], a[40:43], v[168:171], v[228:231]
    ds_read_b128 v[148:151], v21 offset:20480
    buffer_load_dwordx4 v94, s[8:11], s63 offen offset:1024 lds
    v_mfma_f32_16x16x32_bf16 v[248:251], v[168:171], a[44:47], v[248:251]
    ds_read_b128 v[152:155], v21 offset:22528
    v_mfma_f32_16x16x32_bf16 v[212:215], a[36:39], v[172:175], v[212:215]
    v_mfma_f32_16x16x32_bf16 v[232:235], a[40:43], v[172:175], v[232:235]
    buffer_load_dwordx4 v94, s[8:11], s63 offen offset:2048 lds
    v_mfma_f32_16x16x32_bf16 v[252:255], v[172:175], a[44:47], v[252:255]
    s_waitcnt lgkmcnt(0)
    v_mfma_f32_16x16x32_bf16 v[196:199], a[48:51], v[136:139], v[196:199]
    v_mfma_f32_16x16x32_bf16 v[216:219], a[52:55], v[136:139], v[216:219]
    ds_read_b64_tr_b16 a[60:61], v99 offset:61440
    s_add_u32 m0, s87, 33792
    v_lshlrev_b32 v6, 3, v3
    v_mfma_f32_16x16x32_bf16 v[236:239], v[136:139], a[56:59], v[236:239]
    ds_read_b64_tr_b16 a[62:63], v99 offset:61952
    s_add_u32 s63, s86, 512
    buffer_load_dwordx4 v12, s[4:7], s63 offen lds
    v_and_b32 v6, 0x70, v6
    v_mfma_f32_16x16x32_bf16 v[200:203], a[48:51], v[140:143], v[200:203]
    ds_read_b128 v[156:159], v24 offset:2560
    s_add_u32 m0, s88, 12288
    v_mfma_f32_16x16x32_bf16 v[220:223], a[52:55], v[140:143], v[220:223]
    ds_read_b64_tr_b16 a[64:65], v99 offset:62464
    v_mfma_f32_16x16x32_bf16 v[240:243], v[140:143], a[56:59], v[240:243]
    ds_read_b64_tr_b16 a[66:67], v99 offset:62976
    s_mov_b32 s63, 884736
    v_mfma_f32_16x16x32_bf16 v[204:207], a[48:51], v[144:147], v[204:207]
    ds_read_b64_tr_b16 a[68:69], v99 offset:63488
    buffer_load_dwordx4 v94, s[8:11], s63 offen offset:0 lds
    v_mfma_f32_16x16x32_bf16 v[224:227], a[52:55], v[144:147], v[224:227]
    ds_read_b64_tr_b16 a[70:71], v99 offset:64000
    v_mfma_f32_16x16x32_bf16 v[244:247], v[144:147], a[56:59], v[244:247]
    ds_read_b128 v[160:163], v22 offset:16384
    v_mfma_f32_16x16x32_bf16 v[208:211], a[48:51], v[148:151], v[208:211]
    ds_read_b128 v[164:167], v22 offset:18432
    buffer_load_dwordx4 v94, s[8:11], s63 offen offset:1024 lds
    v_mfma_f32_16x16x32_bf16 v[228:231], a[52:55], v[148:151], v[228:231]
    ds_read_b128 v[168:171], v22 offset:20480
    v_mfma_f32_16x16x32_bf16 v[248:251], v[148:151], a[56:59], v[248:251]
    ds_read_b128 v[172:175], v22 offset:22528
    v_mfma_f32_16x16x32_bf16 v[212:215], a[48:51], v[152:155], v[212:215]
    v_mfma_f32_16x16x32_bf16 v[232:235], a[52:55], v[152:155], v[232:235]
    buffer_load_dwordx4 v94, s[8:11], s63 offen offset:2048 lds
    v_mfma_f32_16x16x32_bf16 v[252:255], v[152:155], a[56:59], v[252:255]
    s_waitcnt lgkmcnt(0)
    v_mfma_f32_16x16x32_bf16 v[196:199], a[60:63], v[156:159], v[196:199]
    s_waitcnt vmcnt(9)
    s_barrier
    v_mfma_f32_16x16x32_bf16 v[216:219], a[64:67], v[156:159], v[216:219]
    ds_read_b64_tr_b16 a[72:73], v99 offset:24576
    s_add_u32 m0, s87, 40960
    v_xor_b32 v6, v6, v19
    v_mfma_f32_16x16x32_bf16 v[236:239], v[156:159], a[68:71], v[236:239]
    ds_read_b64_tr_b16 a[74:75], v99 offset:25088
    s_add_u32 s63, s86, 640
    buffer_load_dwordx4 v11, s[4:7], s63 offen lds
    v_lshl_add_u32 v6, v3, 7, v6
    v_mfma_f32_16x16x32_bf16 v[200:203], a[60:63], v[160:163], v[200:203]
    ds_read_b128 v[136:139], v23 offset:3840
    s_add_u32 m0, s88, 49152
    v_mfma_f32_16x16x32_bf16 v[220:223], a[64:67], v[160:163], v[220:223]
    ds_read_b64_tr_b16 a[76:77], v99 offset:25600
    v_mfma_f32_16x16x32_bf16 v[240:243], v[160:163], a[68:71], v[240:243]
    ds_read_b64_tr_b16 a[78:79], v99 offset:26112
    s_mov_b32 s63, 983040
    v_mfma_f32_16x16x32_bf16 v[204:207], a[60:63], v[164:167], v[204:207]
    ds_read_b64_tr_b16 a[80:81], v99 offset:26624
    buffer_load_dwordx4 v94, s[8:11], s63 offen offset:0 lds
    v_mfma_f32_16x16x32_bf16 v[224:227], a[64:67], v[164:167], v[224:227]
    ds_read_b64_tr_b16 a[82:83], v99 offset:27136
    v_mfma_f32_16x16x32_bf16 v[244:247], v[164:167], a[68:71], v[244:247]
    ds_read_b128 v[140:143], v21 offset:24576
    v_mfma_f32_16x16x32_bf16 v[208:211], a[60:63], v[168:171], v[208:211]
    ds_read_b128 v[144:147], v21 offset:26624
    buffer_load_dwordx4 v94, s[8:11], s63 offen offset:1024 lds
    v_mfma_f32_16x16x32_bf16 v[228:231], a[64:67], v[168:171], v[228:231]
    ds_read_b128 v[148:151], v21 offset:28672
    v_mfma_f32_16x16x32_bf16 v[248:251], v[168:171], a[68:71], v[248:251]
    ds_read_b128 v[152:155], v21 offset:30720
    v_mfma_f32_16x16x32_bf16 v[212:215], a[60:63], v[172:175], v[212:215]
    v_mfma_f32_16x16x32_bf16 v[232:235], a[64:67], v[172:175], v[232:235]
    buffer_load_dwordx4 v94, s[8:11], s63 offen offset:2048 lds
    v_mfma_f32_16x16x32_bf16 v[252:255], v[172:175], a[68:71], v[252:255]
    s_waitcnt lgkmcnt(0)
    v_mfma_f32_16x16x32_bf16 v[196:199], a[72:75], v[136:139], v[196:199]
    v_mfma_f32_16x16x32_bf16 v[216:219], a[76:79], v[136:139], v[216:219]
    ds_read_b64_tr_b16 a[84:85], v99 offset:36864
    s_add_u32 m0, s87, 41984
    s_lshl_b32 s60, s53, 13
    v_mfma_f32_16x16x32_bf16 v[236:239], v[136:139], a[80:83], v[236:239]
    ds_read_b64_tr_b16 a[86:87], v99 offset:37376
    s_add_u32 s63, s86, 640
    buffer_load_dwordx4 v12, s[4:7], s63 offen lds
    s_add_u32 s60, s60, s87
    v_mfma_f32_16x16x32_bf16 v[200:203], a[72:75], v[140:143], v[200:203]
    ds_read_b128 v[156:159], v24 offset:3840
    s_add_u32 m0, s88, 61440
    v_mfma_f32_16x16x32_bf16 v[220:223], a[76:79], v[140:143], v[220:223]
    ds_read_b64_tr_b16 a[88:89], v99 offset:37888
    v_mfma_f32_16x16x32_bf16 v[240:243], v[140:143], a[80:83], v[240:243]
    ds_read_b64_tr_b16 a[90:91], v99 offset:38400
    s_mov_b32 s63, 1081344
    v_mfma_f32_16x16x32_bf16 v[204:207], a[72:75], v[144:147], v[204:207]
    ds_read_b64_tr_b16 a[92:93], v99 offset:38912
    buffer_load_dwordx4 v94, s[8:11], s63 offen offset:0 lds
    v_mfma_f32_16x16x32_bf16 v[224:227], a[76:79], v[144:147], v[224:227]
    ds_read_b64_tr_b16 a[94:95], v99 offset:39424
    v_mfma_f32_16x16x32_bf16 v[244:247], v[144:147], a[80:83], v[244:247]
    ds_read_b128 v[160:163], v22 offset:24576
    v_mfma_f32_16x16x32_bf16 v[208:211], a[72:75], v[148:151], v[208:211]
    ds_read_b128 v[164:167], v22 offset:26624
    buffer_load_dwordx4 v94, s[8:11], s63 offen offset:1024 lds
    v_mfma_f32_16x16x32_bf16 v[228:231], a[76:79], v[148:151], v[228:231]
    ds_read_b128 v[168:171], v22 offset:28672
    v_mfma_f32_16x16x32_bf16 v[248:251], v[148:151], a[80:83], v[248:251]
    ds_read_b128 v[172:175], v22 offset:30720
    v_mfma_f32_16x16x32_bf16 v[212:215], a[72:75], v[152:155], v[212:215]
    v_mfma_f32_16x16x32_bf16 v[232:235], a[76:79], v[152:155], v[232:235]
    buffer_load_dwordx4 v94, s[8:11], s63 offen offset:2048 lds
    v_mfma_f32_16x16x32_bf16 v[252:255], v[152:155], a[80:83], v[252:255]
    s_waitcnt lgkmcnt(0)
    v_mfma_f32_16x16x32_bf16 v[196:199], a[84:87], v[156:159], v[196:199]
    s_waitcnt vmcnt(8)
    s_barrier
    v_mfma_f32_16x16x32_bf16 v[216:219], a[88:91], v[156:159], v[216:219]
    ds_read_b64_tr_b16 a[96:97], v99 offset:0
    s_add_u32 m0, s87, 49152
    v_add_u32 v118, s60, v6
    v_mfma_f32_16x16x32_bf16 v[236:239], v[156:159], a[92:95], v[236:239]
    ds_read_b64_tr_b16 a[98:99], v99 offset:512
    s_add_u32 s63, s86, 768
    buffer_load_dwordx4 v11, s[4:7], s63 offen lds
    v_xor_b32 v119, 64, v118
    v_mfma_f32_16x16x32_bf16 v[200:203], a[84:87], v[160:163], v[200:203]
    ds_read_b128 v[136:139], v23 offset:5120
    s_add_u32 m0, s88, 24576
    v_mfma_f32_16x16x32_bf16 v[220:223], a[88:91], v[160:163], v[220:223]
    ds_read_b64_tr_b16 a[100:101], v99 offset:1024
    v_mfma_f32_16x16x32_bf16 v[240:243], v[160:163], a[92:95], v[240:243]
    ds_read_b64_tr_b16 a[102:103], v99 offset:1536
    s_mov_b32 s63, 1179648
    v_mfma_f32_16x16x32_bf16 v[204:207], a[84:87], v[164:167], v[204:207]
    ds_read_b64_tr_b16 a[104:105], v99 offset:2048
    buffer_load_dwordx4 v94, s[8:11], s63 offen offset:0 lds
    v_mfma_f32_16x16x32_bf16 v[224:227], a[88:91], v[164:167], v[224:227]
    ds_read_b64_tr_b16 a[106:107], v99 offset:2560
    v_mfma_f32_16x16x32_bf16 v[244:247], v[164:167], a[92:95], v[244:247]
    ds_read_b128 v[140:143], v21 offset:32768
    v_mfma_f32_16x16x32_bf16 v[208:211], a[84:87], v[168:171], v[208:211]
    ds_read_b128 v[144:147], v21 offset:34816
    buffer_load_dwordx4 v94, s[8:11], s63 offen offset:1024 lds
    v_mfma_f32_16x16x32_bf16 v[228:231], a[88:91], v[168:171], v[228:231]
    ds_read_b128 v[148:151], v21 offset:36864
    v_mfma_f32_16x16x32_bf16 v[248:251], v[168:171], a[92:95], v[248:251]
    ds_read_b128 v[152:155], v21 offset:38912
    v_mfma_f32_16x16x32_bf16 v[212:215], a[84:87], v[172:175], v[212:215]
    v_mfma_f32_16x16x32_bf16 v[232:235], a[88:91], v[172:175], v[232:235]
    buffer_load_dwordx4 v94, s[8:11], s63 offen offset:2048 lds
    v_mfma_f32_16x16x32_bf16 v[252:255], v[172:175], a[92:95], v[252:255]
    s_waitcnt lgkmcnt(0)
    v_mfma_f32_16x16x32_bf16 v[196:199], a[96:99], v[136:139], v[196:199]
    v_mfma_f32_16x16x32_bf16 v[216:219], a[100:103], v[136:139], v[216:219]
    ds_read_b64_tr_b16 a[108:109], v99 offset:12288
    s_add_u32 m0, s87, 50176
    v_mfma_f32_16x16x32_bf16 v[236:239], v[136:139], a[104:107], v[236:239]
    ds_read_b64_tr_b16 a[110:111], v99 offset:12800
    s_add_u32 s63, s86, 768
    buffer_load_dwordx4 v12, s[4:7], s63 offen lds
    v_mfma_f32_16x16x32_bf16 v[200:203], a[96:99], v[140:143], v[200:203]
    ds_read_b128 v[156:159], v24 offset:5120
    s_add_u32 m0, s88, 36864
    v_mfma_f32_16x16x32_bf16 v[220:223], a[100:103], v[140:143], v[220:223]
    ds_read_b64_tr_b16 a[112:113], v99 offset:13312
    s_mov_b32 s63, 1277952
    v_mfma_f32_16x16x32_bf16 v[240:243], v[140:143], a[104:107], v[240:243]
    ds_read_b64_tr_b16 a[114:115], v99 offset:13824
    buffer_load_dwordx4 v94, s[8:11], s63 offen offset:0 lds
    v_mfma_f32_16x16x32_bf16 v[204:207], a[96:99], v[144:147], v[204:207]
    ds_read_b64_tr_b16 a[116:117], v99 offset:14336
    v_mfma_f32_16x16x32_bf16 v[224:227], a[100:103], v[144:147], v[224:227]
    ds_read_b64_tr_b16 a[118:119], v99 offset:14848
    v_mfma_f32_16x16x32_bf16 v[244:247], v[144:147], a[104:107], v[244:247]
    ds_read_b128 v[160:163], v22 offset:32768
    buffer_load_dwordx4 v94, s[8:11], s63 offen offset:1024 lds
    v_mfma_f32_16x16x32_bf16 v[208:211], a[96:99], v[148:151], v[208:211]
    ds_read_b128 v[164:167], v22 offset:34816
    v_mfma_f32_16x16x32_bf16 v[228:231], a[100:103], v[148:151], v[228:231]
    ds_read_b128 v[168:171], v22 offset:36864
    buffer_load_dwordx4 v94, s[8:11], s63 offen offset:2048 lds
    v_mfma_f32_16x16x32_bf16 v[248:251], v[148:151], a[104:107], v[248:251]
    ds_read_b128 v[172:175], v22 offset:38912
    v_mfma_f32_16x16x32_bf16 v[212:215], a[96:99], v[152:155], v[212:215]
    v_mfma_f32_16x16x32_bf16 v[232:235], a[100:103], v[152:155], v[232:235]
    s_cmp_lt_u32 s53, 5
    s_cbranch_scc0 L_res_1
    ds_read_b128 v[52:55], v118
    ds_read_b128 v[56:59], v119
L_res_1:
    v_mfma_f32_16x16x32_bf16 v[252:255], v[152:155], a[104:107], v[252:255]
    s_waitcnt lgkmcnt(0)
    v_mfma_f32_16x16x32_bf16 v[196:199], a[108:111], v[156:159], v[196:199]
    s_waitcnt vmcnt(8)
    s_barrier
    v_mfma_f32_16x16x32_bf16 v[216:219], a[112:115], v[156:159], v[216:219]
    ds_read_b64_tr_b16 a[120:121], v99 offset:49152
    s_add_u32 m0, s87, 57344
    v_mfma_f32_16x16x32_bf16 v[236:239], v[156:159], a[116:119], v[236:239]
    ds_read_b64_tr_b16 a[122:123], v99 offset:49664
    s_add_u32 s63, s86, 896
    buffer_load_dwordx4 v11, s[4:7], s63 offen lds
    v_mfma_f32_16x16x32_bf16 v[200:203], a[108:111], v[160:163], v[200:203]
    ds_read_b128 v[136:139], v23 offset:6400
    s_add_u32 m0, s88, 0
    v_mfma_f32_16x16x32_bf16 v[220:223], a[112:115], v[160:163], v[220:223]
    ds_read_b64_tr_b16 a[124:125], v99 offset:50176
    v_mfma_f32_16x16x32_bf16 v[240:243], v[160:163], a[116:119], v[240:243]
    ds_read_b64_tr_b16 a[126:127], v99 offset:50688
    s_mov_b32 s63, 1376256
    v_mfma_f32_16x16x32_bf16 v[204:207], a[108:111], v[164:167], v[204:207]
    ds_read_b64_tr_b16 a[128:129], v99 offset:51200
    buffer_load_dwordx4 v94, s[8:11], s63 offen offset:0 lds
    v_mfma_f32_16x16x32_bf16 v[224:227], a[112:115], v[164:167], v[224:227]
    ds_read_b64_tr_b16 a[130:131], v99 offset:51712
    v_mfma_f32_16x16x32_bf16 v[244:247], v[164:167], a[116:119], v[244:247]
    ds_read_b128 v[140:143], v21 offset:40960
    v_mfma_f32_16x16x32_bf16 v[208:211], a[108:111], v[168:171], v[208:211]
    ds_read_b128 v[144:147], v21 offset:43008
    buffer_load_dwordx4 v94, s[8:11], s63 offen offset:1024 lds
    v_mfma_f32_16x16x32_bf16 v[228:231], a[112:115], v[168:171], v[228:231]
    ds_read_b128 v[148:151], v21 offset:45056
    v_mfma_f32_16x16x32_bf16 v[248:251], v[168:171], a[116:119], v[248:251]
    ds_read_b128 v[152:155], v21 offset:47104
    v_mfma_f32_16x16x32_bf16 v[212:215], a[108:111], v[172:175], v[212:215]
    v_mfma_f32_16x16x32_bf16 v[232:235], a[112:115], v[172:175], v[232:235]
    buffer_load_dwordx4 v94, s[8:11], s63 offen offset:2048 lds
    v_mfma_f32_16x16x32_bf16 v[252:255], v[172:175], a[116:119], v[252:255]
    s_waitcnt lgkmcnt(0)
    v_mfma_f32_16x16x32_bf16 v[196:199], a[120:123], v[136:139], v[196:199]
    v_mfma_f32_16x16x32_bf16 v[216:219], a[124:127], v[136:139], v[216:219]
    ds_read_b64_tr_b16 a[132:133], v99 offset:61440
    s_add_u32 m0, s87, 58368
    v_mfma_f32_16x16x32_bf16 v[236:239], v[136:139], a[128:131], v[236:239]
    ds_read_b64_tr_b16 a[134:135], v99 offset:61952
    s_add_u32 s63, s86, 896
    buffer_load_dwordx4 v12, s[4:7], s63 offen lds
    v_mfma_f32_16x16x32_bf16 v[200:203], a[120:123], v[140:143], v[200:203]
    ds_read_b128 v[156:159], v24 offset:6400
    s_sub_u32 m0, s88, 75776
    v_mfma_f32_16x16x32_bf16 v[220:223], a[124:127], v[140:143], v[220:223]
    ds_read_b64_tr_b16 a[136:137], v99 offset:62464
    v_mfma_f32_16x16x32_bf16 v[240:243], v[140:143], a[128:131], v[240:243]
    ds_read_b64_tr_b16 a[138:139], v99 offset:62976
    s_mov_b32 s63, 1474560
    v_mfma_f32_16x16x32_bf16 v[204:207], a[120:123], v[144:147], v[204:207]
    ds_read_b64_tr_b16 a[140:141], v99 offset:63488
    buffer_load_dwordx4 v94, s[8:11], s63 offen offset:0 lds
    v_mfma_f32_16x16x32_bf16 v[224:227], a[124:127], v[144:147], v[224:227]
    ds_read_b64_tr_b16 a[142:143], v99 offset:64000
    v_mfma_f32_16x16x32_bf16 v[244:247], v[144:147], a[128:131], v[244:247]
    ds_read_b128 v[160:163], v22 offset:40960
    v_mfma_f32_16x16x32_bf16 v[208:211], a[120:123], v[148:151], v[208:211]
    ds_read_b128 v[164:167], v22 offset:43008
    buffer_load_dwordx4 v94, s[8:11], s63 offen offset:1024 lds
    v_mfma_f32_16x16x32_bf16 v[228:231], a[124:127], v[148:151], v[228:231]
    ds_read_b128 v[168:171], v22 offset:45056
    v_mfma_f32_16x16x32_bf16 v[248:251], v[148:151], a[128:131], v[248:251]
    ds_read_b128 v[172:175], v22 offset:47104
    v_mfma_f32_16x16x32_bf16 v[212:215], a[120:123], v[152:155], v[212:215]
    v_mfma_f32_16x16x32_bf16 v[232:235], a[124:127], v[152:155], v[232:235]
    buffer_load_dwordx4 v94, s[8:11], s63 offen offset:2048 lds
    v_mfma_f32_16x16x32_bf16 v[252:255], v[152:155], a[128:131], v[252:255]
    s_waitcnt lgkmcnt(0)
    v_mfma_f32_16x16x32_bf16 v[196:199], a[132:135], v[156:159], v[196:199]
    s_waitcnt vmcnt(8)
    s_barrier
    v_mfma_f32_16x16x32_bf16 v[216:219], a[136:139], v[156:159], v[216:219]
    ds_read_b64_tr_b16 a[144:145], v99 offset:24576
    v_mfma_f32_16x16x32_bf16 v[236:239], v[156:159], a[140:143], v[236:239]
    ds_read_b64_tr_b16 a[146:147], v99 offset:25088
    v_mfma_f32_16x16x32_bf16 v[200:203], a[132:135], v[160:163], v[200:203]
    ds_read_b128 v[136:139], v23 offset:7680
    buffer_load_dwordx4 v[114:117], v101, s[12:15], 0 offen sc1
    v_mfma_f32_16x16x32_bf16 v[220:223], a[136:139], v[160:163], v[220:223]
    ds_read_b64_tr_b16 a[148:149], v99 offset:25600
    v_mfma_f32_16x16x32_bf16 v[240:243], v[160:163], a[140:143], v[240:243]
    ds_read_b64_tr_b16 a[150:151], v99 offset:26112
    v_mfma_f32_16x16x32_bf16 v[204:207], a[132:135], v[164:167], v[204:207]
    ds_read_b64_tr_b16 a[152:153], v99 offset:26624
    v_mfma_f32_16x16x32_bf16 v[224:227], a[136:139], v[164:167], v[224:227]
    ds_read_b64_tr_b16 a[154:155], v99 offset:27136
    v_mfma_f32_16x16x32_bf16 v[244:247], v[164:167], a[140:143], v[244:247]
    ds_read_b128 v[140:143], v21 offset:49152
    buffer_store_dwordx4 v[104:107], v103, s[12:15], 0 offen sc1
    v_mfma_f32_16x16x32_bf16 v[208:211], a[132:135], v[168:171], v[208:211]
    ds_read_b128 v[144:147], v21 offset:51200
    s_mov_b32 s8, s70
    s_and_b32 s9, s71, 0xffff
    v_mfma_f32_16x16x32_bf16 v[228:231], a[136:139], v[168:171], v[228:231]
    ds_read_b128 v[148:151], v21 offset:53248
    s_mov_b32 s10, 524288
    v_mfma_f32_16x16x32_bf16 v[248:251], v[168:171], a[140:143], v[248:251]
    ds_read_b128 v[152:155], v21 offset:55296
    s_mov_b32 s11, 0x20000
    s_add_u32 m0, s89, 36864
    v_mfma_f32_16x16x32_bf16 v[212:215], a[132:135], v[172:175], v[212:215]
    s_mov_b32 s63, 0
    buffer_load_dwordx4 v92, s[8:11], s63 offen lds
    v_mfma_f32_16x16x32_bf16 v[232:235], a[136:139], v[172:175], v[232:235]
    v_mfma_f32_16x16x32_bf16 v[252:255], v[172:175], a[140:143], v[252:255]
    s_waitcnt lgkmcnt(0)
    v_mfma_f32_16x16x32_bf16 v[196:199], a[144:147], v[136:139], v[196:199]
    v_mfma_f32_16x16x32_bf16 v[216:219], a[148:151], v[136:139], v[216:219]
    ds_read_b64_tr_b16 a[156:157], v99 offset:36864
    s_lshl_b32 s96, s51, 9
    s_add_u32 s96, s96, s52
    s_lshl_b32 s96, s96, 3
    s_add_u32 s96, s96, 6684672
    v_mfma_f32_16x16x32_bf16 v[236:239], v[136:139], a[152:155], v[236:239]
    ds_read_b64_tr_b16 a[158:159], v99 offset:37376
    s_lshl_b32 s60, s50, 30
    v_mov_b32 v103, s60
    s_add_u32 m0, s89, 40960
    s_mov_b32 s63, 32768
    buffer_load_dwordx4 v92, s[8:11], s63 offen lds
    v_mfma_f32_16x16x32_bf16 v[200:203], a[144:147], v[140:143], v[200:203]
    ds_read_b128 v[156:159], v24 offset:7680
    s_add_u32 m0, s89, 45056
    v_mfma_f32_16x16x32_bf16 v[220:223], a[148:151], v[140:143], v[220:223]
    ds_read_b64_tr_b16 a[160:161], v99 offset:37888
    v_mfma_f32_16x16x32_bf16 v[240:243], v[140:143], a[152:155], v[240:243]
    ds_read_b64_tr_b16 a[162:163], v99 offset:38400
    s_mov_b32 s63, 65536
    v_mfma_f32_16x16x32_bf16 v[204:207], a[144:147], v[144:147], v[204:207]
    ds_read_b64_tr_b16 a[164:165], v99 offset:38912
    buffer_load_dwordx4 v92, s[8:11], s63 offen lds
    v_mfma_f32_16x16x32_bf16 v[224:227], a[148:151], v[144:147], v[224:227]
    ds_read_b64_tr_b16 a[166:167], v99 offset:39424
    s_add_u32 m0, s89, 49152
    v_mfma_f32_16x16x32_bf16 v[244:247], v[144:147], a[152:155], v[244:247]
    ds_read_b128 v[160:163], v22 offset:49152
    s_mov_b32 s63, 98304
    v_mfma_f32_16x16x32_bf16 v[208:211], a[144:147], v[148:151], v[208:211]
    ds_read_b128 v[164:167], v22 offset:51200
    buffer_load_dwordx4 v92, s[8:11], s63 offen lds
    v_mfma_f32_16x16x32_bf16 v[228:231], a[148:151], v[148:151], v[228:231]
    ds_read_b128 v[168:171], v22 offset:53248
    s_add_u32 m0, s89, 53248
    v_mfma_f32_16x16x32_bf16 v[248:251], v[148:151], a[152:155], v[248:251]
    ds_read_b128 v[172:175], v22 offset:55296
    v_mfma_f32_16x16x32_bf16 v[212:215], a[144:147], v[152:155], v[212:215]
    s_mov_b32 s63, 131072
    v_mfma_f32_16x16x32_bf16 v[232:235], a[148:151], v[152:155], v[232:235]
    buffer_load_dwordx4 v92, s[8:11], s63 offen lds
    v_mfma_f32_16x16x32_bf16 v[252:255], v[152:155], a[152:155], v[252:255]
    s_mov_b32 s4, s98
    s_and_b32 s5, s99, 0xffff
    s_mov_b32 s6, 1024
    s_mov_b32 s7, 0x20000
    s_waitcnt lgkmcnt(0)
    v_mfma_f32_16x16x32_bf16 v[196:199], a[156:159], v[156:159], v[196:199]
    s_waitcnt vmcnt(7)
    s_barrier
    v_mfma_f32_16x16x32_bf16 v[216:219], a[160:163], v[156:159], v[216:219]
    ds_read_b64_tr_b16 a[168:169], v99 offset:0
    s_add_u32 m0, s89, 57344
    s_lshl_b32 s61, s57, 3
    v_mfma_f32_16x16x32_bf16 v[236:239], v[156:159], a[164:167], v[236:239]
    ds_read_b64_tr_b16 a[170:171], v99 offset:512
    s_mov_b32 s63, 163840
    buffer_load_dwordx4 v92, s[8:11], s63 offen lds
    v_subrev_u32 v8, s61, v0
    v_mfma_f32_16x16x32_bf16 v[200:203], a[156:159], v[160:163], v[200:203]
    ds_read_b128 v[136:139], v23 offset:8960
    s_add_u32 m0, s89, 0
    s_sub_u32 s61, 72, s61
    v_mfma_f32_16x16x32_bf16 v[220:223], a[160:163], v[160:163], v[220:223]
    ds_read_b64_tr_b16 a[172:173], v99 offset:1024
    s_mov_b32 s63, 393216
    buffer_load_dwordx4 v92, s[8:11], s63 offen lds
    v_cmp_gt_u32 s[64:65], s61, v8
    v_mfma_f32_16x16x32_bf16 v[240:243], v[160:163], a[164:167], v[240:243]
    ds_read_b64_tr_b16 a[174:175], v99 offset:1536
    s_add_u32 m0, s89, 4096
    s_mov_b32 s75, 2097152
    v_mfma_f32_16x16x32_bf16 v[204:207], a[156:159], v[164:167], v[204:207]
    ds_read_b64_tr_b16 a[176:177], v99 offset:2048
    s_mov_b32 s63, 425984
    buffer_load_dwordx4 v92, s[8:11], s63 offen lds
    v_lshlrev_b32 v8, 2, v2
    v_mfma_f32_16x16x32_bf16 v[224:227], a[160:163], v[164:167], v[224:227]
    ds_read_b64_tr_b16 a[178:179], v99 offset:2560
    s_lshl_b32 s60, s53, 7
    v_add_u32 v8, 154752, v8
    v_mfma_f32_16x16x32_bf16 v[244:247], v[164:167], a[164:167], v[244:247]
    ds_read_b128 v[140:143], v21 offset:57344
    s_cmp_eq_u32 s50, 2
    s_cselect_b64 s[94:95], -1, s[64:65]
    v_mfma_f32_16x16x32_bf16 v[208:211], a[156:159], v[168:171], v[208:211]
    ds_read_b128 v[144:147], v21 offset:59392
    buffer_load_dwordx4 v[60:63], v19, s[4:7], s60 offen
    v_mfma_f32_16x16x32_bf16 v[228:231], a[160:163], v[168:171], v[228:231]
    ds_read_b128 v[148:151], v21 offset:61440
    v_mfma_f32_16x16x32_bf16 v[248:251], v[168:171], a[164:167], v[248:251]
    ds_read_b128 v[152:155], v21 offset:63488
    buffer_load_dwordx4 v[64:67], v19, s[4:7], s60 offen offset:64
    v_mfma_f32_16x16x32_bf16 v[212:215], a[156:159], v[172:175], v[212:215]
    v_mfma_f32_16x16x32_bf16 v[232:235], a[160:163], v[172:175], v[232:235]
    buffer_load_dwordx4 v[88:91], v5, s[4:7], 0 offen
    v_mfma_f32_16x16x32_bf16 v[252:255], v[172:175], a[164:167], v[252:255]
    s_waitcnt lgkmcnt(0)
    v_mfma_f32_16x16x32_bf16 v[196:199], a[168:171], v[136:139], v[196:199]
    v_mfma_f32_16x16x32_bf16 v[216:219], a[172:175], v[136:139], v[216:219]
    ds_read_b64_tr_b16 a[180:181], v100 offset:0
    v_mfma_f32_16x16x32_bf16 v[236:239], v[136:139], a[176:179], v[236:239]
    ds_read_b64_tr_b16 a[182:183], v100 offset:512
    s_waitcnt vmcnt(12)
L_s0:
    v_xor_b32 v6, s76, v116
    v_xor_b32 v7, s77, v117
    v_lshrrev_b32 v9, 4, v7
    v_or_b32 v6, v6, v9
    v_cmp_ne_u32 vcc, 0, v6
    s_nop 0
    s_and_b64 vcc, vcc, s[94:95]
    s_cbranch_vccnz L_s0r
L_s0ok:
    s_mov_b64 exec, s[64:65]
    ds_write2_b32 v102, v114, v115 offset0:0 offset1:80
    s_mov_b64 exec, -1
    ds_write_b32 v102, v7 offset:608
    v_mfma_f32_16x16x32_bf16 v[200:203], a[168:171], v[140:143], v[200:203]
    ds_read_b128 v[156:159], v24 offset:8960
    s_add_u32 m0, s89, 8192
    v_mfma_f32_16x16x32_bf16 v[220:223], a[172:175], v[140:143], v[220:223]
    ds_read_b64_tr_b16 a[184:185], v100 offset:1024
    s_mov_b32 s63, 458752
    buffer_load_dwordx4 v92, s[8:11], s63 offen lds
    v_mfma_f32_16x16x32_bf16 v[240:243], v[140:143], a[176:179], v[240:243]
    ds_read_b64_tr_b16 a[186:187], v100 offset:1536
    s_sub_u32 m0, s88, 63488
    v_mfma_f32_16x16x32_bf16 v[204:207], a[168:171], v[144:147], v[204:207]
    ds_read_b64_tr_b16 a[188:189], v100 offset:2048
    buffer_load_dwordx4 v96, s[24:27], 0 offen nt lds
    v_mfma_f32_16x16x32_bf16 v[224:227], a[172:175], v[144:147], v[224:227]
    ds_read_b64_tr_b16 a[190:191], v100 offset:2560
    s_sub_u32 m0, s88, 62464
    v_mfma_f32_16x16x32_bf16 v[244:247], v[144:147], a[176:179], v[244:247]
    ds_read_b128 v[160:163], v22 offset:57344
    v_mfma_f32_16x16x32_bf16 v[208:211], a[168:171], v[148:151], v[208:211]
    ds_read_b128 v[164:167], v22 offset:59392
    buffer_load_dwordx4 v97, s[24:27], 0 offen nt lds
    v_mfma_f32_16x16x32_bf16 v[228:231], a[172:175], v[148:151], v[228:231]
    ds_read_b128 v[168:171], v22 offset:61440
    s_sub_u32 m0, s88, 61440
    v_mfma_f32_16x16x32_bf16 v[248:251], v[148:151], a[176:179], v[248:251]
    ds_read_b128 v[172:175], v22 offset:63488
    buffer_load_dwordx4 v98, s[24:27], 0 offen nt lds
    v_mfma_f32_16x16x32_bf16 v[212:215], a[168:171], v[152:155], v[212:215]
    v_mfma_f32_16x16x32_bf16 v[232:235], a[172:175], v[152:155], v[232:235]
    buffer_load_dword v10, v108, s[12:15], 0 offen sc1
    v_mfma_f32_16x16x32_bf16 v[252:255], v[152:155], a[176:179], v[252:255]
    s_waitcnt lgkmcnt(0)
    v_mfma_f32_16x16x32_bf16 v[196:199], a[180:183], v[156:159], v[196:199]
    s_waitcnt vmcnt(12)
    s_barrier
    v_mfma_f32_16x16x32_bf16 v[216:219], a[184:187], v[156:159], v[216:219]
    ds_read_b32 v7, v8
    s_lshl_b32 s60, s50, 12
    ds_read2_b32 v[120:121], v15 offset0:0 offset1:80
    v_mfma_f32_16x16x32_bf16 v[236:239], v[156:159], a[188:191], v[236:239]
    ds_read_b128 v[136:139], v18 offset:0
    s_add_u32 m0, s60, 24576
    s_nop 0
    buffer_load_dwordx4 v93, s[20:23], 0 offen offset:0 nt lds
    ds_read_b128 v[176:179], v18 offset:320
    v_mfma_f32_16x16x32_bf16 v[200:203], a[180:183], v[160:163], v[200:203]
    ds_read2_b32 v[122:123], v15 offset0:16 offset1:96
    v_mfma_f32_16x16x32_bf16 v[220:223], a[184:187], v[160:163], v[220:223]
    ds_read_b128 v[140:143], v18 offset:64
    v_mfma_f32_16x16x32_bf16 v[240:243], v[160:163], a[188:191], v[240:243]
    ds_read_b128 v[180:183], v18 offset:384
    buffer_load_dwordx4 v93, s[20:23], 0 offen offset:1024 nt lds
    v_mfma_f32_16x16x32_bf16 v[204:207], a[180:183], v[164:167], v[204:207]
    ds_read2_b32 v[124:125], v15 offset0:32 offset1:112
    v_mfma_f32_16x16x32_bf16 v[224:227], a[184:187], v[164:167], v[224:227]
    ds_read_b128 v[144:147], v18 offset:128
    v_mfma_f32_16x16x32_bf16 v[244:247], v[164:167], a[188:191], v[244:247]
    ds_read_b128 v[184:187], v18 offset:448
    buffer_load_dwordx4 v93, s[20:23], 0 offen offset:2048 nt lds
    v_mov_b32 v78, v236
    v_mov_b32 v79, v236
    v_mfma_f32_16x16x32_bf16 v[208:211], a[180:183], v[168:171], v[208:211]
    ds_read2_b32 v[126:127], v15 offset0:48 offset1:128
    v_mov_b32_dpp v70, v196 row_newbcast:0 row_mask:0xf bank_mask:0xf
    v_mov_b32_dpp v74, v216 row_newbcast:0 row_mask:0xf bank_mask:0xf
    v_mfma_f32_16x16x32_bf16 v[228:231], a[184:187], v[168:171], v[228:231]
    ds_read_b128 v[148:151], v18 offset:192
    buffer_load_dwordx4 v93, s[20:23], 0 offen offset:3072 nt lds
    v_mov_b32_dpp v71, v197 row_newbcast:0 row_mask:0xf bank_mask:0xf
    v_mov_b32_dpp v75, v217 row_newbcast:0 row_mask:0xf bank_mask:0xf
    v_mfma_f32_16x16x32_bf16 v[248:251], v[168:171], a[188:191], v[248:251]
    ds_read_b128 v[188:191], v18 offset:512
    v_mov_b32_dpp v72, v198 row_newbcast:0 row_mask:0xf bank_mask:0xf
    v_mov_b32_dpp v76, v218 row_newbcast:0 row_mask:0xf bank_mask:0xf
    v_mfma_f32_16x16x32_bf16 v[212:215], a[180:183], v[172:175], v[212:215]
    ds_read2_b32 v[128:129], v15 offset0:64 offset1:144
    v_mov_b32_dpp v73, v199 row_newbcast:0 row_mask:0xf bank_mask:0xf
    v_mov_b32_dpp v77, v219 row_newbcast:0 row_mask:0xf bank_mask:0xf
    v_mfma_f32_16x16x32_bf16 v[232:235], a[184:187], v[172:175], v[232:235]
    ds_read_b128 v[152:155], v18 offset:256
    s_cmp_lt_u32 s53, 5
    s_cbranch_scc1 L_res_2
    ds_read_b128 v[52:55], v118
    ds_read_b128 v[56:59], v119
L_res_2:
    v_permlane32_swap_b32 v78, v79
    v_mfma_f32_16x16x32_bf16 v[252:255], v[172:175], a[188:191], v[252:255]
    ds_read_b128 v[192:195], v18 offset:576
    s_waitcnt lgkmcnt(6)
    v_cmp_ne_u32 vcc, 0, v7
    v_pk_fma_f32 v[216:217], v[74:75], v[120:121], v[216:217] op_sel_hi:[1,0,1]
    v_pk_fma_f32 v[236:237], v[136:137], v[78:79], v[236:237] op_sel_hi:[1,0,1]
    v_pk_fma_f32 v[218:219], v[76:77], v[120:121], v[218:219] op_sel_hi:[1,0,1]
    v_pk_fma_f32 v[238:239], v[138:139], v[78:79], v[238:239] op_sel_hi:[1,0,1]
    v_pk_mul_f32 v[216:217], v[216:217], v[120:121] op_sel:[0,1] op_sel_hi:[1,1]
    v_pk_mul_f32 v[236:237], v[236:237], v[176:177]
    v_pk_mul_f32 v[218:219], v[218:219], v[120:121] op_sel:[0,1] op_sel_hi:[1,1]
    v_pk_mul_f32 v[238:239], v[238:239], v[178:179]
    v_cvt_pk_bf16_f32 v216, v216, v217
    v_cvt_pk_bf16_f32 v217, v218, v219
    s_mov_b64 exec, 1
    buffer_store_dwordx2 v[112:113], v103, s[12:15], s96 offen sc1
    s_mov_b64 exec, -1
    s_cmp_eq_u64 vcc, 0
    s_cselect_b32 s58, 1, 0
    v_pk_fma_f32 v[200:201], v[70:71], v[122:123], v[200:201] op_sel_hi:[1,0,1]
    v_pk_fma_f32 v[220:221], v[74:75], v[122:123], v[220:221] op_sel_hi:[1,0,1]
    v_pk_fma_f32 v[240:241], v[140:141], v[78:79], v[240:241] op_sel_hi:[1,0,1]
    v_pk_fma_f32 v[202:203], v[72:73], v[122:123], v[202:203] op_sel_hi:[1,0,1]
    v_pk_fma_f32 v[222:223], v[76:77], v[122:123], v[222:223] op_sel_hi:[1,0,1]
    v_pk_fma_f32 v[242:243], v[142:143], v[78:79], v[242:243] op_sel_hi:[1,0,1]
    v_pk_mul_f32 v[220:221], v[220:221], v[122:123] op_sel:[0,1] op_sel_hi:[1,1]
    v_pk_mul_f32 v[240:241], v[240:241], v[180:181]
    v_pk_mul_f32 v[222:223], v[222:223], v[122:123] op_sel:[0,1] op_sel_hi:[1,1]
    v_pk_mul_f32 v[242:243], v[242:243], v[182:183]
    v_cvt_pk_bf16_f32 v220, v220, v221
    v_cvt_pk_bf16_f32 v221, v222, v223
    v_cvt_pk_bf16_f32 v200, v200, v201
    v_cvt_pk_bf16_f32 v201, v202, v203
    s_waitcnt lgkmcnt(0)
    v_pk_fma_f32 v[204:205], v[70:71], v[124:125], v[204:205] op_sel_hi:[1,0,1]
    v_pk_fma_f32 v[224:225], v[74:75], v[124:125], v[224:225] op_sel_hi:[1,0,1]
    v_pk_fma_f32 v[244:245], v[144:145], v[78:79], v[244:245] op_sel_hi:[1,0,1]
    v_pk_fma_f32 v[206:207], v[72:73], v[124:125], v[206:207] op_sel_hi:[1,0,1]
    v_pk_fma_f32 v[226:227], v[76:77], v[124:125], v[226:227] op_sel_hi:[1,0,1]
    v_pk_fma_f32 v[246:247], v[146:147], v[78:79], v[246:247] op_sel_hi:[1,0,1]
    v_pk_mul_f32 v[224:225], v[224:225], v[124:125] op_sel:[0,1] op_sel_hi:[1,1]
    v_pk_mul_f32 v[244:245], v[244:245], v[184:185]
    v_pk_mul_f32 v[226:227], v[226:227], v[124:125] op_sel:[0,1] op_sel_hi:[1,1]
    v_pk_mul_f32 v[246:247], v[246:247], v[186:187]
    v_cvt_pk_bf16_f32 v224, v224, v225
    v_cvt_pk_bf16_f32 v225, v226, v227
    v_cvt_pk_bf16_f32 v204, v204, v205
    v_cvt_pk_bf16_f32 v205, v206, v207
    v_pk_fma_f32 v[208:209], v[70:71], v[126:127], v[208:209] op_sel_hi:[1,0,1]
    v_pk_fma_f32 v[228:229], v[74:75], v[126:127], v[228:229] op_sel_hi:[1,0,1]
    v_pk_fma_f32 v[248:249], v[148:149], v[78:79], v[248:249] op_sel_hi:[1,0,1]
    v_pk_fma_f32 v[210:211], v[72:73], v[126:127], v[210:211] op_sel_hi:[1,0,1]
    v_pk_fma_f32 v[230:231], v[76:77], v[126:127], v[230:231] op_sel_hi:[1,0,1]
    v_pk_fma_f32 v[250:251], v[150:151], v[78:79], v[250:251] op_sel_hi:[1,0,1]
    v_pk_mul_f32 v[228:229], v[228:229], v[126:127] op_sel:[0,1] op_sel_hi:[1,1]
    v_pk_mul_f32 v[248:249], v[248:249], v[188:189]
    v_pk_mul_f32 v[230:231], v[230:231], v[126:127] op_sel:[0,1] op_sel_hi:[1,1]
    v_pk_mul_f32 v[250:251], v[250:251], v[190:191]
    v_cvt_pk_bf16_f32 v228, v228, v229
    v_cvt_pk_bf16_f32 v229, v230, v231
    v_cvt_pk_bf16_f32 v208, v208, v209
    v_cvt_pk_bf16_f32 v209, v210, v211
    v_pk_fma_f32 v[212:213], v[70:71], v[128:129], v[212:213] op_sel_hi:[1,0,1]
    v_pk_fma_f32 v[232:233], v[74:75], v[128:129], v[232:233] op_sel_hi:[1,0,1]
    v_pk_fma_f32 v[252:253], v[152:153], v[78:79], v[252:253] op_sel_hi:[1,0,1]
    v_pk_fma_f32 v[214:215], v[72:73], v[128:129], v[214:215] op_sel_hi:[1,0,1]
    v_pk_fma_f32 v[234:235], v[76:77], v[128:129], v[234:235] op_sel_hi:[1,0,1]
    v_pk_fma_f32 v[254:255], v[154:155], v[78:79], v[254:255] op_sel_hi:[1,0,1]
    v_pk_mul_f32 v[232:233], v[232:233], v[128:129] op_sel:[0,1] op_sel_hi:[1,1]
    v_pk_mul_f32 v[252:253], v[252:253], v[192:193]
    v_pk_mul_f32 v[234:235], v[234:235], v[128:129] op_sel:[0,1] op_sel_hi:[1,1]
    v_pk_mul_f32 v[254:255], v[254:255], v[194:195]
    v_cvt_pk_bf16_f32 v232, v232, v233
    v_cvt_pk_bf16_f32 v233, v234, v235
    v_cvt_pk_bf16_f32 v212, v212, v213
    v_cvt_pk_bf16_f32 v213, v214, v215
    v_mfma_f32_16x16x16_bf16 v[134:137], v[220:221], v[204:205], v[30:33]
    v_mul_f32 v186, 0x3eb8aa3b, v123
    v_mul_f32 v188, 0x3eb8aa3b, v125
    v_mfma_f32_16x16x16_bf16 v[150:153], v[224:225], v[204:205], v[34:37]
    v_mul_f32 v190, 0x3eb8aa3b, v127
    v_mul_f32 v192, 0x3eb8aa3b, v129
    v_mfma_f32_16x16x16_bf16 v[138:141], v[224:225], v[208:209], v[30:33]
    v_cvt_pk_bf16_f32 v176, v236, v237
    v_cvt_pk_bf16_f32 v177, v238, v239
    v_mfma_f32_16x16x16_bf16 v[154:157], v[228:229], v[208:209], v[34:37]
    v_cvt_pk_bf16_f32 v178, v240, v241
    v_cvt_pk_bf16_f32 v179, v242, v243
    v_mfma_f32_16x16x16_bf16 v[142:145], v[228:229], v[212:213], v[30:33]
    v_cvt_pk_bf16_f32 v180, v244, v245
    v_cvt_pk_bf16_f32 v181, v246, v247
    v_mfma_f32_16x16x16_bf16 v[158:161], v[232:233], v[212:213], v[34:37]
    v_cvt_pk_bf16_f32 v182, v248, v249
    v_cvt_pk_bf16_f32 v183, v250, v251
    v_mfma_f32_16x16x16_bf16 v[130:133], v[216:217], v[200:201], v[38:41]
    v_cvt_pk_bf16_f32 v184, v252, v253
    v_cvt_pk_bf16_f32 v185, v254, v255
    v_mfma_f32_16x16x16_bf16 v[146:149], v[220:221], v[200:201], v[34:37]
    v_max_f32 v150, v134, v150
    v_max_f32 v151, v135, v151
    v_max_f32 v152, v136, v152
    v_max_f32 v153, v137, v153
    v_max3_f32 v100, v150, v151, v152
    v_max_f32 v100, v100, v153
    v_max_f32 v154, v138, v154
    v_max_f32 v155, v139, v155
    v_max_f32 v156, v140, v156
    v_max_f32 v157, v141, v157
    v_max3_f32 v101, v154, v155, v156
    v_max_f32 v101, v101, v157
    v_max_f32 v158, v142, v158
    v_max_f32 v159, v143, v159
    v_max_f32 v160, v144, v160
    v_max_f32 v161, v145, v161
    v_max3_f32 v102, v158, v159, v160
    v_max_f32 v102, v102, v161
    v_max_f32 v146, v130, v146
    v_max_f32 v147, v131, v147
    v_max_f32 v148, v132, v148
    v_max_f32 v149, v133, v149
    v_max3_f32 v99, v146, v147, v148
    v_max_f32 v99, v99, v149
    v_permlane16_swap_b32 v100, v101
    s_nop 0
    v_permlane16_swap_b32 v102, v99
    v_max_f32 v100, v100, v101
    v_max_f32 v102, v102, v99
    v_mov_b32 v101, v100
    v_mov_b32 v99, v102
    s_nop 0
    v_permlane32_swap_b32 v100, v101
    v_permlane32_swap_b32 v102, v99
    v_max_f32 v100, v100, v101
    v_max_f32 v102, v102, v99
    v_mov_b32 v101, v100
    v_mov_b32 v99, v102
    s_nop 0
    v_permlane16_swap_b32 v100, v101
    v_permlane16_swap_b32 v102, v99
    v_mul_f32 v187, v99, v186
    v_mul_f32 v189, v100, v188
    v_mul_f32 v191, v101, v190
    v_mul_f32 v193, v102, v192
    v_pk_fma_f32 v[146:147], v[146:147], v[186:187], v[186:187] op_sel:[0,0,1] op_sel_hi:[1,0,1] neg_lo:[0,0,1] neg_hi:[0,0,1]
    v_pk_fma_f32 v[148:149], v[148:149], v[186:187], v[186:187] op_sel:[0,0,1] op_sel_hi:[1,0,1] neg_lo:[0,0,1] neg_hi:[0,0,1]
    v_pk_fma_f32 v[150:151], v[150:151], v[188:189], v[188:189] op_sel:[0,0,1] op_sel_hi:[1,0,1] neg_lo:[0,0,1] neg_hi:[0,0,1]
    v_pk_fma_f32 v[152:153], v[152:153], v[188:189], v[188:189] op_sel:[0,0,1] op_sel_hi:[1,0,1] neg_lo:[0,0,1] neg_hi:[0,0,1]
    v_pk_fma_f32 v[154:155], v[154:155], v[190:191], v[190:191] op_sel:[0,0,1] op_sel_hi:[1,0,1] neg_lo:[0,0,1] neg_hi:[0,0,1]
    v_pk_fma_f32 v[156:157], v[156:157], v[190:191], v[190:191] op_sel:[0,0,1] op_sel_hi:[1,0,1] neg_lo:[0,0,1] neg_hi:[0,0,1]
    v_pk_fma_f32 v[158:159], v[158:159], v[192:193], v[192:193] op_sel:[0,0,1] op_sel_hi:[1,0,1] neg_lo:[0,0,1] neg_hi:[0,0,1]
    v_pk_fma_f32 v[160:161], v[160:161], v[192:193], v[192:193] op_sel:[0,0,1] op_sel_hi:[1,0,1] neg_lo:[0,0,1] neg_hi:[0,0,1]
    v_exp_f32 v146, v146
    v_exp_f32 v147, v147
    v_exp_f32 v148, v148
    v_exp_f32 v149, v149
    v_cvt_pk_bf16_f32 v162, v146, v147
    v_cvt_pk_bf16_f32 v163, v148, v149
    v_and_b32 v130, v162, v42
    v_and_b32 v131, v163, v43
    v_xor_b32 v132, v162, v130
    v_xor_b32 v133, v163, v131
    v_exp_f32 v150, v150
    v_mfma_f32_16x16x16_bf16 v[236:239], v[16:17], v[162:163], 0
    v_exp_f32 v151, v151
    v_exp_f32 v152, v152
    v_mfma_f32_16x16x32_bf16 v[146:149], v[176:179], v[130:133], 0
    v_exp_f32 v153, v153
    v_cvt_pk_bf16_f32 v164, v150, v151
    v_cvt_pk_bf16_f32 v165, v152, v153
    v_and_b32 v134, v164, v42
    v_and_b32 v135, v165, v43
    v_xor_b32 v136, v164, v134
    v_xor_b32 v137, v165, v135
    v_exp_f32 v154, v154
    v_mfma_f32_16x16x16_bf16 v[240:243], v[16:17], v[164:165], 0
    v_exp_f32 v155, v155
    v_exp_f32 v156, v156
    v_mfma_f32_16x16x32_bf16 v[150:153], v[178:181], v[134:137], 0
    v_exp_f32 v157, v157
    v_cvt_pk_bf16_f32 v166, v154, v155
    v_cvt_pk_bf16_f32 v167, v156, v157
    v_and_b32 v138, v166, v42
    v_and_b32 v139, v167, v43
    v_xor_b32 v140, v166, v138
    v_xor_b32 v141, v167, v139
    v_exp_f32 v158, v158
    v_mfma_f32_16x16x16_bf16 v[244:247], v[16:17], v[166:167], 0
    v_exp_f32 v159, v159
    v_exp_f32 v160, v160
    v_mfma_f32_16x16x32_bf16 v[154:157], v[180:183], v[138:141], 0
    v_exp_f32 v161, v161
    v_cvt_pk_bf16_f32 v168, v158, v159
    v_cvt_pk_bf16_f32 v169, v160, v161
    v_and_b32 v142, v168, v42
    v_and_b32 v143, v169, v43
    v_xor_b32 v144, v168, v142
    v_xor_b32 v145, v169, v143
    v_mfma_f32_16x16x16_bf16 v[248:251], v[16:17], v[168:169], 0
    v_rcp_f32 v236, v236
    v_mfma_f32_16x16x32_bf16 v[158:161], v[182:185], v[142:145], 0
    v_rcp_f32 v240, v240
    v_rcp_f32 v244, v244
    v_pk_mul_f32 v[146:147], v[146:147], v[236:237] op_sel_hi:[1,0]
    v_pk_mul_f32 v[148:149], v[148:149], v[236:237] op_sel_hi:[1,0]
    v_cvt_pk_bf16_f32 v80, v146, v147
    v_cvt_pk_bf16_f32 v81, v148, v149
    v_pk_mul_f32 v[150:151], v[150:151], v[240:241] op_sel_hi:[1,0]
    v_pk_mul_f32 v[152:153], v[152:153], v[240:241] op_sel_hi:[1,0]
    v_cvt_pk_bf16_f32 v82, v150, v151
    v_cvt_pk_bf16_f32 v83, v152, v153
    s_nop 0
    v_permlane16_swap_b32 v80, v82
    v_permlane16_swap_b32 v81, v83
    v_pk_mul_f32 v[154:155], v[154:155], v[244:245] op_sel_hi:[1,0]
    v_pk_mul_f32 v[156:157], v[156:157], v[244:245] op_sel_hi:[1,0]
    v_cvt_pk_bf16_f32 v84, v154, v155
    v_cvt_pk_bf16_f32 v85, v156, v157
    v_rcp_f32 v248, v248
    s_nop 0
    v_pk_mul_f32 v[158:159], v[158:159], v[248:249] op_sel_hi:[1,0]
    v_pk_mul_f32 v[160:161], v[160:161], v[248:249] op_sel_hi:[1,0]
    v_cvt_pk_bf16_f32 v86, v158, v159
    v_cvt_pk_bf16_f32 v87, v160, v161
    s_nop 0
    v_permlane16_swap_b32 v84, v86
    v_permlane16_swap_b32 v85, v87
L_pub:
    s_mov_b32 s60, 32768
    s_and_b32 s61, s58, s59
    s_cbranch_scc0 L_opr
    buffer_store_dwordx4 v[80:83], v20, s[12:15], 0 offen
    buffer_store_dwordx4 v[84:87], v20, s[12:15], s60 offen
L_opd:
    v_permlane16_swap_b32 v52, v54
    v_permlane16_swap_b32 v53, v55
    v_permlane16_swap_b32 v56, v58
    v_permlane16_swap_b32 v57, v59
    v_lshlrev_b32 v94, 16, v52
    v_and_b32 v95, 0xffff0000, v52
    v_lshlrev_b32 v96, 16, v53
    v_and_b32 v97, 0xffff0000, v53
    v_lshlrev_b32 v98, 16, v54
    v_and_b32 v99, 0xffff0000, v54
    v_lshlrev_b32 v100, 16, v55
    v_and_b32 v101, 0xffff0000, v55
    v_lshlrev_b32 v102, 16, v56
    v_and_b32 v103, 0xffff0000, v56
    v_lshlrev_b32 v104, 16, v57
    v_and_b32 v105, 0xffff0000, v57
    v_lshlrev_b32 v106, 16, v58
    v_and_b32 v107, 0xffff0000, v58
    v_lshlrev_b32 v108, 16, v59
    v_and_b32 v109, 0xffff0000, v59
    s_mov_b32 s64, 4096
    s_cmp_lg_u32 s59, 0
    s_cbranch_scc1 L_p5
    s_mov_b32 s93, s76
    v_mov_b32 v44, s76
    v_mov_b32 v45, s77
    ds_read_b64_tr_b16 v[174:175], v25 offset:36864
    ds_read_b64_tr_b16 v[176:177], v25 offset:37376
    ds_read_b64_tr_b16 v[178:179], v26 offset:36864
    ds_read_b64_tr_b16 v[180:181], v26 offset:37376
    ds_read_b64_tr_b16 v[182:183], v27 offset:36864
    ds_read_b64_tr_b16 v[184:185], v27 offset:37376
    ds_read_b64_tr_b16 v[186:187], v28 offset:36864
    ds_read_b64_tr_b16 v[188:189], v28 offset:37376
    ds_read_b64_tr_b16 v[190:191], v25 offset:40960
    ds_read_b64_tr_b16 v[192:193], v25 offset:41472
    ds_read_b64_tr_b16 v[194:195], v26 offset:40960
    ds_read_b64_tr_b16 v[196:197], v26 offset:41472
    ds_read_b64_tr_b16 v[198:199], v27 offset:40960
    ds_read_b64_tr_b16 v[200:201], v27 offset:41472
    ds_read_b64_tr_b16 v[202:203], v28 offset:40960
    ds_read_b64_tr_b16 v[204:205], v28 offset:41472
    ds_read_b64_tr_b16 v[206:207], v25 offset:45056
    ds_read_b64_tr_b16 v[208:209], v25 offset:45568
    ds_read_b64_tr_b16 v[210:211], v26 offset:45056
    ds_read_b64_tr_b16 v[212:213], v26 offset:45568
    ds_read_b64_tr_b16 v[214:215], v27 offset:45056
    ds_read_b64_tr_b16 v[216:217], v27 offset:45568
    ds_read_b64_tr_b16 v[218:219], v28 offset:45056
    ds_read_b64_tr_b16 v[220:221], v28 offset:45568
    s_waitcnt vmcnt(0)
    s_mov_b64 exec, 1
    s_cmp_eq_u32 s58, 0
    s_cbranch_scc1 L_rem_3
    buffer_store_dwordx2 v[44:45], v5, s[12:15], s29 offen
L_st_4:
    s_nop 0
    s_mov_b64 exec, -1
    ds_read_b64_tr_b16 v[222:223], v25 offset:49152
    ds_read_b64_tr_b16 v[224:225], v25 offset:49664
    ds_read_b64_tr_b16 v[226:227], v26 offset:49152
    s_add_u32 m0, s89, 61440
    s_mov_b32 s63, 491520
    buffer_load_dwordx4 v92, s[8:11], s63 offen lds
    ds_read_b64_tr_b16 v[228:229], v26 offset:49664
    ds_read_b64_tr_b16 v[230:231], v27 offset:49152
    ds_read_b64_tr_b16 v[232:233], v27 offset:49664
    s_add_u32 m0, s89, 12288
    s_mov_b32 s63, 196608
    buffer_load_dwordx4 v92, s[8:11], s63 offen lds
    ds_read_b64_tr_b16 v[234:235], v28 offset:49152
    ds_read_b64_tr_b16 v[236:237], v28 offset:49664
    v_lshrrev_b32 v6, 3, v2
    s_add_u32 m0, s89, 16384
    s_mov_b32 s63, 229376
    buffer_load_dwordx4 v92, s[8:11], s63 offen lds
    v_lshlrev_b32 v6, 10, v6
    v_sub_u32 v11, v11, v6
    v_xor_b32 v12, 64, v11
    s_add_u32 m0, s89, 20480
    s_mov_b32 s63, 262144
    buffer_load_dwordx4 v92, s[8:11], s63 offen lds
    v_add_u32 v12, 8192, v12
    v_lshlrev_b32 v8, 2, v6
    v_and_b32 v9, 7, v2
    s_add_u32 m0, s89, 24576
    s_mov_b32 s63, 294912
    buffer_load_dwordx4 v92, s[8:11], s63 offen lds
    v_lshl_add_u32 v8, v9, 5, v8
    v_add_u32 v8, 6684672, v8
    v_and_b32 v9, 127, v0
    s_add_u32 m0, s89, 28672
    s_mov_b32 s63, 327680
    buffer_load_dwordx4 v92, s[8:11], s63 offen lds
    v_lshlrev_b32 v9, 3, v9
    s_add_u32 m0, s89, 32768
    s_mov_b32 s63, 360448
    buffer_load_dwordx4 v92, s[8:11], s63 offen lds
    buffer_load_dwordx2 v[238:239], v49, s[12:15], s28 offen sc1
    s_mov_b32 vcc_lo, 0x11111111
    s_mov_b32 vcc_hi, 0x11111111
    v_permlane16_swap_b32 v60, v62
    v_permlane16_swap_b32 v61, v63
    v_permlane16_swap_b32 v64, v66
    v_permlane16_swap_b32 v65, v67
    v_cndmask_b32 v60, v60, v16, vcc
    v_cndmask_b32 v61, v61, v16, vcc
    v_cndmask_b32 v62, v62, v16, vcc
    v_cndmask_b32 v63, v63, v16, vcc
    v_cndmask_b32 v64, v64, v16, vcc
    v_cndmask_b32 v65, v65, v16, vcc
    v_cndmask_b32 v66, v66, v16, vcc
    v_cndmask_b32 v67, v67, v16, vcc
    v_mov_b32 v68, 0
    v_dot2c_f32_bf16 v68, v88, v16
    v_dot2c_f32_bf16 v68, v89, v16
    v_dot2c_f32_bf16 v68, v90, v16
    v_dot2c_f32_bf16 v68, v91, v16
    s_nop 2
    v_add_f32_dpp v68, v68, v68 row_ror:8 row_mask:0xf bank_mask:0xf
    s_nop 1
    v_add_f32_dpp v68, v68, v68 row_ror:4 row_mask:0xf bank_mask:0xf
    s_nop 1
    v_add_f32_dpp v68, v68, v68 row_ror:2 row_mask:0xf bank_mask:0xf
    s_nop 1
    v_add_f32_dpp v68, v68, v68 row_ror:1 row_mask:0xf bank_mask:0xf
    v_mov_b32 v6, v68
    s_nop 1
    v_permlane16_swap_b32 v68, v6
    v_add_f32 v68, v68, v6
    v_mov_b32 v6, v68
    s_nop 1
    v_permlane32_swap_b32 v68, v6
    v_add_f32 v68, v68, v6
    s_mov_b32 s75, 2097152
L_rp_5:
    s_waitcnt vmcnt(0)
    v_xor_b32 v239, s77, v239
    v_xor_b32 v238, s76, v238
    v_lshrrev_b32 v239, 4, v239
    v_or_b32 v238, v238, v239
    v_cmp_ne_u32 vcc, 0, v238
    s_nop 0
    s_cbranch_vccz L_ok_6
    buffer_load_dwordx2 v[238:239], v49, s[12:15], s28 offen sc1
    s_sub_u32 s75, s75, 1
    s_cbranch_scc0 L_rp_5
L_ok_6:
    buffer_load_dwordx4 v[110:113], v50, s[12:15], 0 offen offset:0 sc1
    buffer_load_dwordx4 v[114:117], v50, s[12:15], 0 offen offset:1024 sc1
    buffer_load_dwordx4 v[118:121], v50, s[12:15], 0 offen offset:2048 sc1
    s_barrier
    buffer_load_dwordx4 v[122:125], v50, s[12:15], 0 offen offset:3072 sc1
    ds_read_b64_tr_b16 v[240:241], v13 offset:0
    ds_read_b64_tr_b16 v[242:243], v13 offset:1536
    buffer_load_dwordx4 v[126:129], v50, s[12:15], s64 offen offset:0 sc1
    ds_read_b64_tr_b16 v[244:245], v13 offset:128
    ds_read_b64_tr_b16 v[246:247], v13 offset:1664
    buffer_load_dwordx4 v[130:133], v50, s[12:15], s64 offen offset:1024 sc1
    ds_read_b64_tr_b16 v[248:249], v13 offset:256
    ds_read_b64_tr_b16 v[250:251], v13 offset:1792
    buffer_load_dwordx4 v[134:137], v50, s[12:15], s64 offen offset:2048 sc1
    buffer_load_dwordx4 v[138:141], v50, s[12:15], s64 offen offset:3072 sc1
    buffer_load_dwordx4 v[142:145], v51, s[12:15], 0 offen offset:0 sc1
    buffer_load_dwordx4 v[146:149], v51, s[12:15], 0 offen offset:1024 sc1
    s_cmp_eq_u32 s51, 7
    s_cselect_b32 s60, 1, 3
    s_cmp_lt_u32 s50, s60
    s_cselect_b32 s60, 0, 0x40000000
    v_add_u32 v13, s60, v14
    s_waitcnt vmcnt(9) lgkmcnt(6)
    v_mfma_f32_16x16x32_bf16 v[94:97], v[174:177], v[110:113], v[94:97]
    buffer_load_dwordx4 v[150:153], v51, s[12:15], 0 offen offset:2048 sc1
    ds_read_b64_tr_b16 v[174:175], v25 offset:53248
    ds_read_b64_tr_b16 v[176:177], v25 offset:53760
    v_mfma_f32_16x16x32_bf16 v[98:101], v[178:181], v[110:113], v[98:101]
    ds_read_b64_tr_b16 v[178:179], v26 offset:53248
    ds_read_b64_tr_b16 v[180:181], v26 offset:53760
    v_mfma_f32_16x16x32_bf16 v[102:105], v[182:185], v[110:113], v[102:105]
    ds_read_b64_tr_b16 v[182:183], v27 offset:53248
    ds_read_b64_tr_b16 v[184:185], v27 offset:53760
    v_mfma_f32_16x16x32_bf16 v[106:109], v[186:189], v[110:113], v[106:109]
    ds_read_b64_tr_b16 v[186:187], v28 offset:53248
    ds_read_b64_tr_b16 v[188:189], v28 offset:53760
    s_waitcnt vmcnt(9) lgkmcnt(14)
    v_mfma_f32_16x16x32_bf16 v[94:97], v[190:193], v[114:117], v[94:97]
    buffer_load_dwordx4 v[154:157], v51, s[12:15], 0 offen offset:3072 sc1
    ds_read_b64_tr_b16 v[190:191], v25 offset:57344
    ds_read_b64_tr_b16 v[192:193], v25 offset:57856
    v_mfma_f32_16x16x32_bf16 v[98:101], v[194:197], v[114:117], v[98:101]
    ds_read_b64_tr_b16 v[194:195], v26 offset:57344
    ds_read_b64_tr_b16 v[196:197], v26 offset:57856
    v_mfma_f32_16x16x32_bf16 v[102:105], v[198:201], v[114:117], v[102:105]
    ds_read_b64_tr_b16 v[198:199], v27 offset:57344
    ds_read_b64_tr_b16 v[200:201], v27 offset:57856
    v_mfma_f32_16x16x32_bf16 v[106:109], v[202:205], v[114:117], v[106:109]
    ds_read_b64_tr_b16 v[202:203], v28 offset:57344
    ds_read_b64_tr_b16 v[204:205], v28 offset:57856
    s_waitcnt vmcnt(9) lgkmcnt(14)
    v_mfma_f32_16x16x32_bf16 v[94:97], v[206:209], v[118:121], v[94:97]
    buffer_load_dwordx4 v[158:161], v51, s[12:15], s64 offen offset:0 sc1
    ds_read_b64_tr_b16 v[206:207], v25 offset:12288
    ds_read_b64_tr_b16 v[208:209], v25 offset:12800
    v_mfma_f32_16x16x32_bf16 v[98:101], v[210:213], v[118:121], v[98:101]
    ds_read_b64_tr_b16 v[210:211], v26 offset:12288
    ds_read_b64_tr_b16 v[212:213], v26 offset:12800
    v_mfma_f32_16x16x32_bf16 v[102:105], v[214:217], v[118:121], v[102:105]
    ds_read_b64_tr_b16 v[214:215], v27 offset:12288
    ds_read_b64_tr_b16 v[216:217], v27 offset:12800
    v_mfma_f32_16x16x32_bf16 v[106:109], v[218:221], v[118:121], v[106:109]
    ds_read_b64_tr_b16 v[218:219], v28 offset:12288
    ds_read_b64_tr_b16 v[220:221], v28 offset:12800
    s_waitcnt vmcnt(9) lgkmcnt(14)
    v_mfma_f32_16x16x32_bf16 v[94:97], v[222:225], v[122:125], v[94:97]
    buffer_load_dwordx4 v[162:165], v51, s[12:15], s64 offen offset:1024 sc1
    ds_read_b64_tr_b16 v[222:223], v25 offset:16384
    ds_read_b64_tr_b16 v[224:225], v25 offset:16896
    v_mfma_f32_16x16x32_bf16 v[98:101], v[226:229], v[122:125], v[98:101]
    ds_read_b64_tr_b16 v[226:227], v26 offset:16384
    ds_read_b64_tr_b16 v[228:229], v26 offset:16896
    v_mfma_f32_16x16x32_bf16 v[102:105], v[230:233], v[122:125], v[102:105]
    ds_read_b64_tr_b16 v[230:231], v27 offset:16384
    ds_read_b64_tr_b16 v[232:233], v27 offset:16896
    v_mfma_f32_16x16x32_bf16 v[106:109], v[234:237], v[122:125], v[106:109]
    ds_read_b64_tr_b16 v[234:235], v28 offset:16384
    ds_read_b64_tr_b16 v[236:237], v28 offset:16896
    s_waitcnt vmcnt(9) lgkmcnt(14)
    v_mfma_f32_16x16x32_bf16 v[94:97], v[174:177], v[126:129], v[94:97]
    buffer_load_dwordx4 v[166:169], v51, s[12:15], s64 offen offset:2048 sc1
    ds_read_b64_tr_b16 v[174:175], v25 offset:20480
    ds_read_b64_tr_b16 v[176:177], v25 offset:20992
    v_mfma_f32_16x16x32_bf16 v[98:101], v[178:181], v[126:129], v[98:101]
    ds_read_b64_tr_b16 v[178:179], v26 offset:20480
    ds_read_b64_tr_b16 v[180:181], v26 offset:20992
    v_mfma_f32_16x16x32_bf16 v[102:105], v[182:185], v[126:129], v[102:105]
    ds_read_b64_tr_b16 v[182:183], v27 offset:20480
    ds_read_b64_tr_b16 v[184:185], v27 offset:20992
    v_mfma_f32_16x16x32_bf16 v[106:109], v[186:189], v[126:129], v[106:109]
    ds_read_b64_tr_b16 v[186:187], v28 offset:20480
    ds_read_b64_tr_b16 v[188:189], v28 offset:20992
    s_waitcnt vmcnt(9) lgkmcnt(14)
    v_mfma_f32_16x16x32_bf16 v[94:97], v[190:193], v[130:133], v[94:97]
    buffer_load_dwordx4 v[170:173], v51, s[12:15], s64 offen offset:3072 sc1
    ds_read_b64_tr_b16 v[190:191], v25 offset:24576
    ds_read_b64_tr_b16 v[192:193], v25 offset:25088
    v_mfma_f32_16x16x32_bf16 v[98:101], v[194:197], v[130:133], v[98:101]
    ds_read_b64_tr_b16 v[194:195], v26 offset:24576
    ds_read_b64_tr_b16 v[196:197], v26 offset:25088
    v_mfma_f32_16x16x32_bf16 v[102:105], v[198:201], v[130:133], v[102:105]
    ds_read_b64_tr_b16 v[198:199], v27 offset:24576
    ds_read_b64_tr_b16 v[200:201], v27 offset:25088
    v_mfma_f32_16x16x32_bf16 v[106:109], v[202:205], v[130:133], v[106:109]
    ds_read_b64_tr_b16 v[202:203], v28 offset:24576
    ds_read_b64_tr_b16 v[204:205], v28 offset:25088
    s_waitcnt vmcnt(9) lgkmcnt(14)
    v_mfma_f32_16x16x32_bf16 v[94:97], v[206:209], v[134:137], v[94:97]
    buffer_load_dwordx4 v[80:83], v8, s[12:15], 0 offen sc1
    buffer_load_dwordx4 v[84:87], v8, s[12:15], 0 offen offset:16 sc1
    ds_read_b64_tr_b16 v[206:207], v25 offset:28672
    ds_read_b64_tr_b16 v[208:209], v25 offset:29184
    v_mfma_f32_16x16x32_bf16 v[98:101], v[210:213], v[134:137], v[98:101]
    ds_read_b64_tr_b16 v[210:211], v26 offset:28672
    ds_read_b64_tr_b16 v[212:213], v26 offset:29184
    v_mfma_f32_16x16x32_bf16 v[102:105], v[214:217], v[134:137], v[102:105]
    ds_read_b64_tr_b16 v[214:215], v27 offset:28672
    ds_read_b64_tr_b16 v[216:217], v27 offset:29184
    v_mfma_f32_16x16x32_bf16 v[106:109], v[218:221], v[134:137], v[106:109]
    ds_read_b64_tr_b16 v[218:219], v28 offset:28672
    ds_read_b64_tr_b16 v[220:221], v28 offset:29184
    s_waitcnt vmcnt(10) lgkmcnt(14)
    v_mfma_f32_16x16x32_bf16 v[94:97], v[222:225], v[138:141], v[94:97]
    s_mov_b32 s60, 0
    buffer_store_dwordx4 v[240:243], v14, s[12:15], s60 offen sc1
    ds_read_b64_tr_b16 v[222:223], v25 offset:32768
    ds_read_b64_tr_b16 v[224:225], v25 offset:33280
    v_mfma_f32_16x16x32_bf16 v[98:101], v[226:229], v[138:141], v[98:101]
    ds_read_b64_tr_b16 v[226:227], v26 offset:32768
    ds_read_b64_tr_b16 v[228:229], v26 offset:33280
    v_mfma_f32_16x16x32_bf16 v[102:105], v[230:233], v[138:141], v[102:105]
    ds_read_b64_tr_b16 v[230:231], v27 offset:32768
    ds_read_b64_tr_b16 v[232:233], v27 offset:33280
    v_mfma_f32_16x16x32_bf16 v[106:109], v[234:237], v[138:141], v[106:109]
    ds_read_b64_tr_b16 v[234:235], v28 offset:32768
    ds_read_b64_tr_b16 v[236:237], v28 offset:33280
    s_waitcnt vmcnt(10) lgkmcnt(14)
    v_mfma_f32_16x16x32_bf16 v[94:97], v[174:177], v[142:145], v[94:97]
    s_mov_b32 s60, 131072
    buffer_store_dwordx4 v[244:247], v14, s[12:15], s60 offen sc1
    ds_read_b64_tr_b16 v[174:175], v25 offset:0
    ds_read_b64_tr_b16 v[176:177], v25 offset:512
    v_mfma_f32_16x16x32_bf16 v[98:101], v[178:181], v[142:145], v[98:101]
    ds_read_b64_tr_b16 v[178:179], v26 offset:0
    ds_read_b64_tr_b16 v[180:181], v26 offset:512
    v_mfma_f32_16x16x32_bf16 v[102:105], v[182:185], v[142:145], v[102:105]
    ds_read_b64_tr_b16 v[182:183], v27 offset:0
    ds_read_b64_tr_b16 v[184:185], v27 offset:512
    v_mfma_f32_16x16x32_bf16 v[106:109], v[186:189], v[142:145], v[106:109]
    ds_read_b64_tr_b16 v[186:187], v28 offset:0
    ds_read_b64_tr_b16 v[188:189], v28 offset:512
    s_waitcnt vmcnt(10) lgkmcnt(14)
    v_mfma_f32_16x16x32_bf16 v[94:97], v[190:193], v[146:149], v[94:97]
    s_mov_b32 s60, 262144
    buffer_store_dwordx4 v[248:251], v13, s[12:15], s60 offen sc1
    ds_read_b64_tr_b16 v[190:191], v25 offset:4096
    ds_read_b64_tr_b16 v[192:193], v25 offset:4608
    v_mfma_f32_16x16x32_bf16 v[98:101], v[194:197], v[146:149], v[98:101]
    ds_read_b64_tr_b16 v[194:195], v26 offset:4096
    ds_read_b64_tr_b16 v[196:197], v26 offset:4608
    v_mfma_f32_16x16x32_bf16 v[102:105], v[198:201], v[146:149], v[102:105]
    ds_read_b64_tr_b16 v[198:199], v27 offset:4096
    ds_read_b64_tr_b16 v[200:201], v27 offset:4608
    v_mfma_f32_16x16x32_bf16 v[106:109], v[202:205], v[146:149], v[106:109]
    ds_read_b64_tr_b16 v[202:203], v28 offset:4096
    ds_read_b64_tr_b16 v[204:205], v28 offset:4608
    s_waitcnt vmcnt(10) lgkmcnt(14)
    v_mfma_f32_16x16x32_bf16 v[94:97], v[206:209], v[150:153], v[94:97]
    ds_read_b64_tr_b16 v[206:207], v25 offset:8192
    ds_read_b64_tr_b16 v[208:209], v25 offset:8704
    v_mfma_f32_16x16x32_bf16 v[98:101], v[210:213], v[150:153], v[98:101]
    ds_read_b64_tr_b16 v[210:211], v26 offset:8192
    ds_read_b64_tr_b16 v[212:213], v26 offset:8704
    v_mfma_f32_16x16x32_bf16 v[102:105], v[214:217], v[150:153], v[102:105]
    ds_read_b64_tr_b16 v[214:215], v27 offset:8192
    ds_read_b64_tr_b16 v[216:217], v27 offset:8704
    v_mfma_f32_16x16x32_bf16 v[106:109], v[218:221], v[150:153], v[106:109]
    ds_read_b64_tr_b16 v[218:219], v28 offset:8192
    ds_read_b64_tr_b16 v[220:221], v28 offset:8704
    s_waitcnt vmcnt(9) lgkmcnt(14)
    v_mfma_f32_16x16x32_bf16 v[94:97], v[222:225], v[154:157], v[94:97]
    ds_read_b64_tr_b16 v[222:223], v25 offset:61440
    ds_read_b64_tr_b16 v[224:225], v25 offset:61952
    v_mfma_f32_16x16x32_bf16 v[98:101], v[226:229], v[154:157], v[98:101]
    ds_read_b64_tr_b16 v[226:227], v26 offset:61440
    ds_read_b64_tr_b16 v[228:229], v26 offset:61952
    v_mfma_f32_16x16x32_bf16 v[102:105], v[230:233], v[154:157], v[102:105]
    ds_read_b64_tr_b16 v[230:231], v27 offset:61440
    ds_read_b64_tr_b16 v[232:233], v27 offset:61952
    v_mfma_f32_16x16x32_bf16 v[106:109], v[234:237], v[154:157], v[106:109]
    ds_read_b64_tr_b16 v[234:235], v28 offset:61440
    ds_read_b64_tr_b16 v[236:237], v28 offset:61952
    s_waitcnt vmcnt(8) lgkmcnt(14)
    v_mfma_f32_16x16x32_bf16 v[94:97], v[174:177], v[158:161], v[94:97]
    ds_read_b64 a[224:225], v9 offset:24576
    v_mfma_f32_16x16x32_bf16 v[98:101], v[178:181], v[158:161], v[98:101]
    ds_read_b64 a[226:227], v9 offset:25600
    v_mfma_f32_16x16x32_bf16 v[102:105], v[182:185], v[158:161], v[102:105]
    ds_read_b64 a[228:229], v9 offset:26624
    v_mfma_f32_16x16x32_bf16 v[106:109], v[186:189], v[158:161], v[106:109]
    ds_read_b64 a[230:231], v9 offset:27648
    s_waitcnt vmcnt(7) lgkmcnt(14)
    v_mfma_f32_16x16x32_bf16 v[94:97], v[190:193], v[162:165], v[94:97]
    ds_read_b64 a[232:233], v9 offset:28672
    v_mfma_f32_16x16x32_bf16 v[98:101], v[194:197], v[162:165], v[98:101]
    ds_read_b64 a[234:235], v9 offset:29696
    v_mfma_f32_16x16x32_bf16 v[102:105], v[198:201], v[162:165], v[102:105]
    ds_read_b64 a[236:237], v9 offset:30720
    v_mfma_f32_16x16x32_bf16 v[106:109], v[202:205], v[162:165], v[106:109]
    ds_read_b64 a[238:239], v9 offset:31744
    s_waitcnt vmcnt(6) lgkmcnt(14)
    v_mfma_f32_16x16x32_bf16 v[94:97], v[206:209], v[166:169], v[94:97]
    ds_read_b64 a[240:241], v9 offset:32768
    v_mfma_f32_16x16x32_bf16 v[98:101], v[210:213], v[166:169], v[98:101]
    ds_read_b64 a[242:243], v9 offset:33792
    v_mfma_f32_16x16x32_bf16 v[102:105], v[214:217], v[166:169], v[102:105]
    ds_read_b64 a[244:245], v9 offset:34816
    v_mfma_f32_16x16x32_bf16 v[106:109], v[218:221], v[166:169], v[106:109]
    ds_read_b64 a[246:247], v9 offset:35840
    s_waitcnt vmcnt(5) lgkmcnt(12)
    v_mfma_f32_16x16x32_bf16 v[94:97], v[222:225], v[170:173], v[94:97]
    ds_read_b64 a[248:249], v9 offset:36864
    v_mfma_f32_16x16x32_bf16 v[98:101], v[226:229], v[170:173], v[98:101]
    ds_read_b64 a[250:251], v9 offset:37888
    v_mfma_f32_16x16x32_bf16 v[102:105], v[230:233], v[170:173], v[102:105]
    ds_read_b64 a[252:253], v9 offset:38912
    v_mfma_f32_16x16x32_bf16 v[106:109], v[234:237], v[170:173], v[106:109]
    ds_read_b64 a[254:255], v9 offset:39936
    s_branch L_p2e
L_p5:
    ds_read_b64_tr_b16 v[174:175], v25 offset:36864
    ds_read_b64_tr_b16 v[176:177], v25 offset:37376
    ds_read_b64_tr_b16 v[178:179], v26 offset:36864
    ds_read_b64_tr_b16 v[180:181], v26 offset:37376
    ds_read_b64_tr_b16 v[182:183], v27 offset:36864
    ds_read_b64_tr_b16 v[184:185], v27 offset:37376
    ds_read_b64_tr_b16 v[186:187], v28 offset:36864
    ds_read_b64_tr_b16 v[188:189], v28 offset:37376
    ds_read_b64_tr_b16 v[190:191], v25 offset:40960
    ds_read_b64_tr_b16 v[192:193], v25 offset:41472
    ds_read_b64_tr_b16 v[194:195], v26 offset:40960
    ds_read_b64_tr_b16 v[196:197], v26 offset:41472
    ds_read_b64_tr_b16 v[198:199], v27 offset:40960
    ds_read_b64_tr_b16 v[200:201], v27 offset:41472
    ds_read_b64_tr_b16 v[202:203], v28 offset:40960
    ds_read_b64_tr_b16 v[204:205], v28 offset:41472
    s_waitcnt vmcnt(0)
    s_mov_b64 exec, 1
    s_cmp_eq_u32 s58, 0
    s_cbranch_scc1 L_rem_7
    buffer_store_dwordx2 v[44:45], v5, s[12:15], s29 offen
L_st_8:
    s_nop 0
    s_mov_b64 exec, -1
    ds_read_b64_tr_b16 v[206:207], v25 offset:45056
    ds_read_b64_tr_b16 v[208:209], v25 offset:45568
    ds_read_b64_tr_b16 v[210:211], v26 offset:45056
    ds_read_b64_tr_b16 v[212:213], v26 offset:45568
    ds_read_b64_tr_b16 v[214:215], v27 offset:45056
    ds_read_b64_tr_b16 v[216:217], v27 offset:45568
    ds_read_b64_tr_b16 v[218:219], v28 offset:45056
    ds_read_b64_tr_b16 v[220:221], v28 offset:45568
    ds_read_b64_tr_b16 v[222:223], v25 offset:49152
    ds_read_b64_tr_b16 v[224:225], v25 offset:49664
    ds_read_b64_tr_b16 v[226:227], v26 offset:49152
    ds_read_b64_tr_b16 v[228:229], v26 offset:49664
    ds_read_b64_tr_b16 v[230:231], v27 offset:49152
    ds_read_b64_tr_b16 v[232:233], v27 offset:49664
    ds_read_b64_tr_b16 v[234:235], v28 offset:49152
    ds_read_b64_tr_b16 v[236:237], v28 offset:49664
    buffer_load_dwordx2 v[238:239], v49, s[12:15], s28 offen sc1
    ds_read_b64_tr_b16 a[0:1], v25 offset:53248
    ds_read_b64_tr_b16 a[2:3], v25 offset:53760
    ds_read_b64_tr_b16 a[4:5], v26 offset:53248
    ds_read_b64_tr_b16 a[6:7], v26 offset:53760
    ds_read_b64_tr_b16 a[8:9], v27 offset:53248
    ds_read_b64_tr_b16 a[10:11], v27 offset:53760
    ds_read_b64_tr_b16 a[12:13], v28 offset:53248
    ds_read_b64_tr_b16 a[14:15], v28 offset:53760
    ds_read_b64_tr_b16 a[16:17], v25 offset:57344
    ds_read_b64_tr_b16 a[18:19], v25 offset:57856
    ds_read_b64_tr_b16 a[20:21], v26 offset:57344
    ds_read_b64_tr_b16 a[22:23], v26 offset:57856
    ds_read_b64_tr_b16 a[24:25], v27 offset:57344
    ds_read_b64_tr_b16 a[26:27], v27 offset:57856
    ds_read_b64_tr_b16 a[28:29], v28 offset:57344
    ds_read_b64_tr_b16 a[30:31], v28 offset:57856
    ds_read_b64_tr_b16 a[32:33], v25 offset:12288
    ds_read_b64_tr_b16 a[34:35], v25 offset:12800
    ds_read_b64_tr_b16 a[36:37], v26 offset:12288
    ds_read_b64_tr_b16 a[38:39], v26 offset:12800
    ds_read_b64_tr_b16 a[40:41], v27 offset:12288
    ds_read_b64_tr_b16 a[42:43], v27 offset:12800
    ds_read_b64_tr_b16 a[44:45], v28 offset:12288
    ds_read_b64_tr_b16 a[46:47], v28 offset:12800
    s_mov_b32 s75, 2097152
L_rp_9:
    s_waitcnt vmcnt(0)
    v_xor_b32 v239, s77, v239
    v_xor_b32 v238, s76, v238
    v_lshrrev_b32 v239, 4, v239
    v_or_b32 v238, v238, v239
    v_cmp_ne_u32 vcc, 0, v238
    s_nop 0
    s_cbranch_vccz L_ok_10
    buffer_load_dwordx2 v[238:239], v49, s[12:15], s28 offen sc1
    s_sub_u32 s75, s75, 1
    s_cbranch_scc0 L_rp_9
L_ok_10:
    buffer_load_dwordx4 v[110:113], v50, s[12:15], 0 offen offset:0 sc1
    ds_read_b64_tr_b16 a[48:49], v25 offset:16384
    ds_read_b64_tr_b16 a[50:51], v25 offset:16896
    ds_read_b64_tr_b16 a[52:53], v26 offset:16384
    buffer_load_dwordx4 v[114:117], v50, s[12:15], 0 offen offset:1024 sc1
    ds_read_b64_tr_b16 a[54:55], v26 offset:16896
    ds_read_b64_tr_b16 a[56:57], v27 offset:16384
    ds_read_b64_tr_b16 a[58:59], v27 offset:16896
    buffer_load_dwordx4 v[118:121], v50, s[12:15], 0 offen offset:2048 sc1
    ds_read_b64_tr_b16 a[60:61], v28 offset:16384
    ds_read_b64_tr_b16 a[62:63], v28 offset:16896
    ds_read_b64_tr_b16 a[64:65], v25 offset:20480
    buffer_load_dwordx4 v[122:125], v50, s[12:15], 0 offen offset:3072 sc1
    ds_read_b64_tr_b16 a[66:67], v25 offset:20992
    ds_read_b64_tr_b16 a[68:69], v26 offset:20480
    ds_read_b64_tr_b16 a[70:71], v26 offset:20992
    buffer_load_dwordx4 v[126:129], v50, s[12:15], s64 offen offset:0 sc1
    ds_read_b64_tr_b16 a[72:73], v27 offset:20480
    ds_read_b64_tr_b16 a[74:75], v27 offset:20992
    ds_read_b64_tr_b16 a[76:77], v28 offset:20480
    buffer_load_dwordx4 v[130:133], v50, s[12:15], s64 offen offset:1024 sc1
    ds_read_b64_tr_b16 a[78:79], v28 offset:20992
    ds_read_b64_tr_b16 a[80:81], v25 offset:24576
    ds_read_b64_tr_b16 a[82:83], v25 offset:25088
    buffer_load_dwordx4 v[134:137], v50, s[12:15], s64 offen offset:2048 sc1
    ds_read_b64_tr_b16 a[84:85], v26 offset:24576
    ds_read_b64_tr_b16 a[86:87], v26 offset:25088
    ds_read_b64_tr_b16 a[88:89], v27 offset:24576
    buffer_load_dwordx4 v[138:141], v50, s[12:15], s64 offen offset:3072 sc1
    ds_read_b64_tr_b16 a[90:91], v27 offset:25088
    ds_read_b64_tr_b16 a[92:93], v28 offset:24576
    ds_read_b64_tr_b16 a[94:95], v28 offset:25088
    s_waitcnt vmcnt(7) lgkmcnt(14)
    v_mfma_f32_16x16x32_bf16 v[94:97], v[174:177], v[110:113], v[94:97]
    buffer_load_dwordx4 v[142:145], v51, s[12:15], 0 offen offset:0 sc1
    ds_read_b64_tr_b16 a[96:97], v25 offset:28672
    ds_read_b64_tr_b16 a[98:99], v25 offset:29184
    v_mfma_f32_16x16x32_bf16 v[98:101], v[178:181], v[110:113], v[98:101]
    ds_read_b64_tr_b16 a[100:101], v26 offset:28672
    ds_read_b64_tr_b16 a[102:103], v26 offset:29184
    v_mfma_f32_16x16x32_bf16 v[102:105], v[182:185], v[110:113], v[102:105]
    ds_read_b64_tr_b16 a[104:105], v27 offset:28672
    ds_read_b64_tr_b16 a[106:107], v27 offset:29184
    v_mfma_f32_16x16x32_bf16 v[106:109], v[186:189], v[110:113], v[106:109]
    ds_read_b64_tr_b16 a[108:109], v28 offset:28672
    ds_read_b64_tr_b16 a[110:111], v28 offset:29184
    s_waitcnt vmcnt(7) lgkmcnt(14)
    v_mfma_f32_16x16x32_bf16 v[94:97], v[190:193], v[114:117], v[94:97]
    buffer_load_dwordx4 v[146:149], v51, s[12:15], 0 offen offset:1024 sc1
    ds_read_b64_tr_b16 a[112:113], v25 offset:32768
    ds_read_b64_tr_b16 a[114:115], v25 offset:33280
    v_mfma_f32_16x16x32_bf16 v[98:101], v[194:197], v[114:117], v[98:101]
    ds_read_b64_tr_b16 a[116:117], v26 offset:32768
    ds_read_b64_tr_b16 a[118:119], v26 offset:33280
    v_mfma_f32_16x16x32_bf16 v[102:105], v[198:201], v[114:117], v[102:105]
    ds_read_b64_tr_b16 a[120:121], v27 offset:32768
    ds_read_b64_tr_b16 a[122:123], v27 offset:33280
    v_mfma_f32_16x16x32_bf16 v[106:109], v[202:205], v[114:117], v[106:109]
    ds_read_b64_tr_b16 a[124:125], v28 offset:32768
    ds_read_b64_tr_b16 a[126:127], v28 offset:33280
    s_waitcnt vmcnt(7) lgkmcnt(14)
    v_mfma_f32_16x16x32_bf16 v[94:97], v[206:209], v[118:121], v[94:97]
    buffer_load_dwordx4 v[150:153], v51, s[12:15], 0 offen offset:2048 sc1
    ds_read_b64_tr_b16 a[128:129], v25 offset:0
    ds_read_b64_tr_b16 a[130:131], v25 offset:512
    v_mfma_f32_16x16x32_bf16 v[98:101], v[210:213], v[118:121], v[98:101]
    ds_read_b64_tr_b16 a[132:133], v26 offset:0
    ds_read_b64_tr_b16 a[134:135], v26 offset:512
    v_mfma_f32_16x16x32_bf16 v[102:105], v[214:217], v[118:121], v[102:105]
    ds_read_b64_tr_b16 a[136:137], v27 offset:0
    ds_read_b64_tr_b16 a[138:139], v27 offset:512
    v_mfma_f32_16x16x32_bf16 v[106:109], v[218:221], v[118:121], v[106:109]
    ds_read_b64_tr_b16 a[140:141], v28 offset:0
    ds_read_b64_tr_b16 a[142:143], v28 offset:512
    s_waitcnt vmcnt(7) lgkmcnt(14)
    v_mfma_f32_16x16x32_bf16 v[94:97], v[222:225], v[122:125], v[94:97]
    buffer_load_dwordx4 v[154:157], v51, s[12:15], 0 offen offset:3072 sc1
    ds_read_b64_tr_b16 a[144:145], v25 offset:4096
    ds_read_b64_tr_b16 a[146:147], v25 offset:4608
    v_mfma_f32_16x16x32_bf16 v[98:101], v[226:229], v[122:125], v[98:101]
    ds_read_b64_tr_b16 a[148:149], v26 offset:4096
    ds_read_b64_tr_b16 a[150:151], v26 offset:4608
    v_mfma_f32_16x16x32_bf16 v[102:105], v[230:233], v[122:125], v[102:105]
    ds_read_b64_tr_b16 a[152:153], v27 offset:4096
    ds_read_b64_tr_b16 a[154:155], v27 offset:4608
    v_mfma_f32_16x16x32_bf16 v[106:109], v[234:237], v[122:125], v[106:109]
    ds_read_b64_tr_b16 a[156:157], v28 offset:4096
    ds_read_b64_tr_b16 a[158:159], v28 offset:4608
    s_waitcnt vmcnt(7) lgkmcnt(14)
    v_mfma_f32_16x16x32_bf16 v[94:97], a[0:3], v[126:129], v[94:97]
    buffer_load_dwordx4 v[158:161], v51, s[12:15], s64 offen offset:0 sc1
    ds_read_b64_tr_b16 a[160:161], v25 offset:8192
    ds_read_b64_tr_b16 a[162:163], v25 offset:8704
    v_mfma_f32_16x16x32_bf16 v[98:101], a[4:7], v[126:129], v[98:101]
    ds_read_b64_tr_b16 a[164:165], v26 offset:8192
    ds_read_b64_tr_b16 a[166:167], v26 offset:8704
    v_mfma_f32_16x16x32_bf16 v[102:105], a[8:11], v[126:129], v[102:105]
    ds_read_b64_tr_b16 a[168:169], v27 offset:8192
    ds_read_b64_tr_b16 a[170:171], v27 offset:8704
    v_mfma_f32_16x16x32_bf16 v[106:109], a[12:15], v[126:129], v[106:109]
    ds_read_b64_tr_b16 a[172:173], v28 offset:8192
    ds_read_b64_tr_b16 a[174:175], v28 offset:8704
    s_waitcnt vmcnt(7) lgkmcnt(14)
    v_mfma_f32_16x16x32_bf16 v[94:97], a[16:19], v[130:133], v[94:97]
    buffer_load_dwordx4 v[162:165], v51, s[12:15], s64 offen offset:1024 sc1
    ds_read_b64_tr_b16 a[176:177], v25 offset:61440
    ds_read_b64_tr_b16 a[178:179], v25 offset:61952
    v_mfma_f32_16x16x32_bf16 v[98:101], a[20:23], v[130:133], v[98:101]
    ds_read_b64_tr_b16 a[180:181], v26 offset:61440
    ds_read_b64_tr_b16 a[182:183], v26 offset:61952
    v_mfma_f32_16x16x32_bf16 v[102:105], a[24:27], v[130:133], v[102:105]
    ds_read_b64_tr_b16 a[184:185], v27 offset:61440
    ds_read_b64_tr_b16 a[186:187], v27 offset:61952
    v_mfma_f32_16x16x32_bf16 v[106:109], a[28:31], v[130:133], v[106:109]
    ds_read_b64_tr_b16 a[188:189], v28 offset:61440
    ds_read_b64_tr_b16 a[190:191], v28 offset:61952
    s_waitcnt vmcnt(7) lgkmcnt(0)
    v_mfma_f32_16x16x32_bf16 v[94:97], a[32:35], v[134:137], v[94:97]
    buffer_load_dwordx4 v[166:169], v51, s[12:15], s64 offen offset:2048 sc1
    v_mfma_f32_16x16x32_bf16 v[98:101], a[36:39], v[134:137], v[98:101]
    v_mfma_f32_16x16x32_bf16 v[102:105], a[40:43], v[134:137], v[102:105]
    v_mfma_f32_16x16x32_bf16 v[106:109], a[44:47], v[134:137], v[106:109]
    s_waitcnt vmcnt(7)
    v_mfma_f32_16x16x32_bf16 v[94:97], a[48:51], v[138:141], v[94:97]
    buffer_load_dwordx4 v[170:173], v51, s[12:15], s64 offen offset:3072 sc1
    v_mfma_f32_16x16x32_bf16 v[98:101], a[52:55], v[138:141], v[98:101]
    v_mfma_f32_16x16x32_bf16 v[102:105], a[56:59], v[138:141], v[102:105]
    v_mfma_f32_16x16x32_bf16 v[106:109], a[60:63], v[138:141], v[106:109]
    s_waitcnt vmcnt(7)
    v_mfma_f32_16x16x32_bf16 v[94:97], a[64:67], v[142:145], v[94:97]
    v_mfma_f32_16x16x32_bf16 v[98:101], a[68:71], v[142:145], v[98:101]
    v_mfma_f32_16x16x32_bf16 v[102:105], a[72:75], v[142:145], v[102:105]
    v_mfma_f32_16x16x32_bf16 v[106:109], a[76:79], v[142:145], v[106:109]
    s_waitcnt vmcnt(6)
    v_mfma_f32_16x16x32_bf16 v[94:97], a[80:83], v[146:149], v[94:97]
    v_mfma_f32_16x16x32_bf16 v[98:101], a[84:87], v[146:149], v[98:101]
    v_mfma_f32_16x16x32_bf16 v[102:105], a[88:91], v[146:149], v[102:105]
    v_mfma_f32_16x16x32_bf16 v[106:109], a[92:95], v[146:149], v[106:109]
    s_waitcnt vmcnt(5)
    v_mfma_f32_16x16x32_bf16 v[94:97], a[96:99], v[150:153], v[94:97]
    v_mfma_f32_16x16x32_bf16 v[98:101], a[100:103], v[150:153], v[98:101]
    v_mfma_f32_16x16x32_bf16 v[102:105], a[104:107], v[150:153], v[102:105]
    v_mfma_f32_16x16x32_bf16 v[106:109], a[108:111], v[150:153], v[106:109]
    s_waitcnt vmcnt(4)
    v_mfma_f32_16x16x32_bf16 v[94:97], a[112:115], v[154:157], v[94:97]
    v_mfma_f32_16x16x32_bf16 v[98:101], a[116:119], v[154:157], v[98:101]
    v_mfma_f32_16x16x32_bf16 v[102:105], a[120:123], v[154:157], v[102:105]
    v_mfma_f32_16x16x32_bf16 v[106:109], a[124:127], v[154:157], v[106:109]
    s_waitcnt vmcnt(3)
    v_mfma_f32_16x16x32_bf16 v[94:97], a[128:131], v[158:161], v[94:97]
    v_mfma_f32_16x16x32_bf16 v[98:101], a[132:135], v[158:161], v[98:101]
    v_mfma_f32_16x16x32_bf16 v[102:105], a[136:139], v[158:161], v[102:105]
    v_mfma_f32_16x16x32_bf16 v[106:109], a[140:143], v[158:161], v[106:109]
    s_waitcnt vmcnt(2)
    v_mfma_f32_16x16x32_bf16 v[94:97], a[144:147], v[162:165], v[94:97]
    v_mfma_f32_16x16x32_bf16 v[98:101], a[148:151], v[162:165], v[98:101]
    v_mfma_f32_16x16x32_bf16 v[102:105], a[152:155], v[162:165], v[102:105]
    v_mfma_f32_16x16x32_bf16 v[106:109], a[156:159], v[162:165], v[106:109]
    s_waitcnt vmcnt(1)
    v_mfma_f32_16x16x32_bf16 v[94:97], a[160:163], v[166:169], v[94:97]
    v_mfma_f32_16x16x32_bf16 v[98:101], a[164:167], v[166:169], v[98:101]
    v_mfma_f32_16x16x32_bf16 v[102:105], a[168:171], v[166:169], v[102:105]
    v_mfma_f32_16x16x32_bf16 v[106:109], a[172:175], v[166:169], v[106:109]
    s_waitcnt vmcnt(0)
    v_mfma_f32_16x16x32_bf16 v[94:97], a[176:179], v[170:173], v[94:97]
    v_mfma_f32_16x16x32_bf16 v[98:101], a[180:183], v[170:173], v[98:101]
    v_mfma_f32_16x16x32_bf16 v[102:105], a[184:187], v[170:173], v[102:105]
    v_mfma_f32_16x16x32_bf16 v[106:109], a[188:191], v[170:173], v[106:109]
L_p2e:
    s_nop 3
    s_nop 0
    v_cvt_pk_bf16_f32 v52, v94, v95
    v_cvt_pk_bf16_f32 v53, v96, v97
    v_cvt_pk_bf16_f32 v54, v98, v99
    v_cvt_pk_bf16_f32 v55, v100, v101
    v_cvt_pk_bf16_f32 v56, v102, v103
    v_cvt_pk_bf16_f32 v57, v104, v105
    v_mfma_f32_16x16x32_bf16 v[88:91], v[52:55], v[52:55], 0
    v_cvt_pk_bf16_f32 v58, v106, v107
    v_cvt_pk_bf16_f32 v59, v108, v109
    v_mfma_f32_16x16x32_bf16 v[110:113], v[60:63], v[52:55], 0
    v_permlane16_swap_b32 v52, v54
    v_mfma_f32_16x16x32_bf16 v[88:91], v[56:59], v[56:59], v[88:91]
    v_permlane16_swap_b32 v53, v55
    v_mfma_f32_16x16x32_bf16 v[110:113], v[64:67], v[56:59], v[110:113]
    v_permlane16_swap_b32 v56, v58
    v_permlane16_swap_b32 v57, v59
    v_lshlrev_b32 v94, 16, v52
    v_and_b32 v95, 0xffff0000, v52
    v_lshlrev_b32 v96, 16, v53
    v_and_b32 v97, 0xffff0000, v53
    v_cndmask_b32 v6, v88, v89, s[66:67]
    v_cndmask_b32 v7, v90, v91, s[66:67]
    v_cndmask_b32 v112, v6, v7, s[68:69]
    v_mov_b32 v113, s93
    s_mov_b32 exec_lo, 0x00f0000f
    s_mov_b32 exec_hi, 0xf0000f00
    s_cmp_eq_u32 s58, 0
    s_cbranch_scc1 L_rem_11
    buffer_store_dwordx4 v[110:113], v48, s[12:15], s31 offen
L_st_12:
    s_nop 0
    s_mov_b64 exec, -1
    v_lshlrev_b32 v98, 16, v54
    v_and_b32 v99, 0xffff0000, v54
    v_lshlrev_b32 v100, 16, v55
    v_and_b32 v101, 0xffff0000, v55
    v_lshlrev_b32 v102, 16, v56
    v_and_b32 v103, 0xffff0000, v56
    v_lshlrev_b32 v104, 16, v57
    v_and_b32 v105, 0xffff0000, v57
    v_lshlrev_b32 v106, 16, v58
    v_and_b32 v107, 0xffff0000, v58
    v_lshlrev_b32 v108, 16, v59
    v_and_b32 v109, 0xffff0000, v59
    v_lshrrev_b32 v6, 3, v2
    v_and_b32 v7, 0x70, v5
    v_lshl_add_u32 v92, v6, 10, v7
    s_cmp_lg_u32 s59, 0
    s_cbranch_scc1 L_sk_13
    s_cmp_lg_u32 s50, 3
    s_cbranch_scc1 L_sk_14
    v_lshl_add_u32 v6, v3, 7, v19
    v_add_u32 v6, 79872, v6
    v_add_u32 v7, 80896, v5
    ds_write_b128 v6, v[52:55]
    ds_write_b128 v6, v[56:59] offset:64
    s_waitcnt lgkmcnt(0)
    ds_read_b128 v[88:91], v7
L_sk_14:
    s_mov_b32 s75, 2097152
    s_waitcnt vmcnt(4)
L_hel_15:
    v_xor_b32 v80, s76, v80
    v_xor_b32 v81, s77, v81
    v_xor_b32 v82, s76, v82
    v_xor_b32 v83, s77, v83
    v_xor_b32 v84, s76, v84
    v_xor_b32 v85, s77, v85
    v_xor_b32 v86, s76, v86
    v_xor_b32 v87, s77, v87
    v_or3_b32 v6, v81, v83, v85
    v_or_b32 v6, v6, v87
    v_lshrrev_b32 v6, 4, v6
    v_or3_b32 v6, v6, v80, v82
    v_or3_b32 v6, v6, v84, v86
    v_cmp_ne_u32 vcc, 0, v6
    s_nop 0
    s_cbranch_vccz L_helok_16
    s_sleep 8
    buffer_load_dwordx4 v[80:83], v8, s[12:15], 0 offen sc1
    buffer_load_dwordx4 v[84:87], v8, s[12:15], 0 offen offset:16 sc1
    s_waitcnt vmcnt(0)
    s_sub_u32 s75, s75, 1
    s_cbranch_scc0 L_hel_15
L_helok_16:
L_sk_13:
    buffer_load_dwordx4 v[114:117], v5, s[12:15], s30 offen sc1
    buffer_load_dwordx4 v[118:121], v5, s[12:15], s30 offen offset:1024 sc1
    s_mov_b32 s75, 2097152
L_rp_17:
    s_waitcnt vmcnt(0)
    v_cmp_ne_u32 vcc, s93, v117
    v_cmp_ne_u32 s[62:63], s93, v121
    v_pk_add_f32 v[114:115], v[114:115], v[118:119]
    s_or_b64 vcc, vcc, s[62:63]
    s_cbranch_vccz L_ok_18
    buffer_load_dwordx4 v[114:117], v5, s[12:15], s30 offen sc1
    buffer_load_dwordx4 v[118:121], v5, s[12:15], s30 offen offset:1024 sc1
    s_sub_u32 s75, s75, 1
    s_cbranch_scc0 L_rp_17
L_ok_18:
    v_add_f32 v116, v116, v120
    v_mov_b32 v118, v114
    v_mov_b32 v119, v115
    v_mov_b32 v120, v116
    s_cmp_eq_u32 s58, 0
    s_cbranch_scc1 L_rem_19
    buffer_store_dwordx4 v[52:55], v46, s[12:15], s38 offen
    buffer_store_dwordx4 v[56:59], v46, s[12:15], s38 offen offset:64
L_st_20:
    s_nop 0
    v_permlane16_swap_b32 v114, v118
    v_permlane16_swap_b32 v115, v119
    v_permlane16_swap_b32 v116, v120
    v_pk_add_f32 v[114:115], v[114:115], v[118:119]
    v_add_f32 v116, v116, v120
    v_mov_b32 v118, v114
    v_mov_b32 v119, v115
    v_mov_b32 v120, v116
    v_permlane32_swap_b32 v114, v118
    v_permlane32_swap_b32 v115, v119
    v_permlane32_swap_b32 v116, v120
    v_pk_add_f32 v[114:115], v[114:115], v[118:119]
    v_add_f32 v116, v116, v120
    v_mul_f32 v80, 0x3b000000, v114
    v_mul_f32 v81, 0x3b000000, v116
    v_fma_f32 v81, -v80, v80, v81
    v_max_f32 v81, 0, v81
    v_cvt_pk_bf16_f32 v6, 0, v81
    v_add_f32 v6, 0x3727c5ac, v6
    v_cvt_pk_bf16_f32 v6, 0, v6
    v_sqrt_f32 v6, v6
    v_cvt_pk_bf16_f32 v84, 0, v80
    v_cvt_pk_bf16_f32 v6, 0, v6
    v_rcp_f32 v82, v6
    v_fma_f32 v85, -v84, v68, v115
    v_mul_f32 v85, v85, v82
    v_mul_f32 v83, -v84, v82
    v_ashrrev_i32 v6, 31, v85
    v_or_b32 v6, 0x80000000, v6
    v_xor_b32 v85, v85, v6
    v_and_b32 v85, 0xfffff800, v85
    v_or3_b32 v85, v85, v3, s44
    v_pk_fma_f32 v[130:131], v[94:95], v[82:83], v[82:83] op_sel:[0,0,1] op_sel_hi:[1,0,1]
    v_pk_fma_f32 v[132:133], v[96:97], v[82:83], v[82:83] op_sel:[0,0,1] op_sel_hi:[1,0,1]
    v_max_u32_dpp v86, v85, v85 quad_perm:[1,0,3,2] row_mask:0xf bank_mask:0xf
    v_min_u32_dpp v87, v85, v85 quad_perm:[1,0,3,2] row_mask:0xf bank_mask:0xf
    v_pk_fma_f32 v[134:135], v[98:99], v[82:83], v[82:83] op_sel:[0,0,1] op_sel_hi:[1,0,1]
    v_min_u32_dpp v6, v86, v86 quad_perm:[2,3,0,1] row_mask:0xf bank_mask:0xf
    v_max_u32_dpp v7, v87, v87 quad_perm:[2,3,0,1] row_mask:0xf bank_mask:0xf
    v_max_u32_dpp v86, v86, v86 quad_perm:[2,3,0,1] row_mask:0xf bank_mask:0xf
    v_max_u32 v87, v6, v7
    v_pk_fma_f32 v[136:137], v[100:101], v[82:83], v[82:83] op_sel:[0,0,1] op_sel_hi:[1,0,1]
    v_min_u32_dpp v6, v86, v86 row_half_mirror row_mask:0xf bank_mask:0xf
    v_max_u32_dpp v7, v87, v87 row_half_mirror row_mask:0xf bank_mask:0xf
    v_max_u32_dpp v86, v86, v86 row_half_mirror row_mask:0xf bank_mask:0xf
    v_max_u32 v87, v6, v7
    v_pk_fma_f32 v[138:139], v[102:103], v[82:83], v[82:83] op_sel:[0,0,1] op_sel_hi:[1,0,1]
    v_min_u32_dpp v6, v86, v86 row_mirror row_mask:0xf bank_mask:0xf
    v_max_u32_dpp v7, v87, v87 row_mirror row_mask:0xf bank_mask:0xf
    v_max_u32_dpp v86, v86, v86 row_mirror row_mask:0xf bank_mask:0xf
    v_max_u32 v87, v6, v7
    s_mov_b64 exec, 1
    buffer_store_dwordx2 v[86:87], v5, s[12:15], s32 offen sc1
    s_cmp_lg_u32 s59, 0
    s_cbranch_scc1 L_sk_21
    s_waitcnt vmcnt(1)
    s_cmp_eq_u32 s58, 0
    s_cbranch_scc1 L_rem_22
    buffer_store_dwordx2 v[44:45], v5, s[12:15], s40 offen
L_st_23:
    s_nop 0
    s_mov_b32 exec_lo, 0x11111111
    s_mov_b32 exec_hi, 0
    s_mov_b32 s60, 0
    buffer_load_dword v10, v14, s[12:15], s60 offen sc1
    s_mov_b32 s60, 131072
    buffer_load_dword v10, v14, s[12:15], s60 offen sc1
    s_mov_b32 s60, 262144
    buffer_load_dword v10, v13, s[12:15], s60 offen sc1
    s_mov_b64 exec, -1
    s_cmp_lg_u32 s50, 3
    s_cbranch_scc1 L_sk_21
    s_mov_b64 exec, -1
    s_add_u32 s60, s34, 2064384
    s_waitcnt lgkmcnt(0)
    buffer_store_dwordx4 v[88:91], v92, s[12:15], s60 offen sc1
L_sk_21:
    s_mov_b64 exec, -1
    v_cmp_eq_u32 vcc, v85, v87
    v_add_u32 v8, 256, v47
    s_lshl_b32 s60, s50, 11
    s_add_u32 s60, s60, s34
    v_add_u32 v7, 1024, v19
    v_cndmask_b32 v7, v19, v7, vcc
    v_pk_fma_f32 v[140:141], v[104:105], v[82:83], v[82:83] op_sel:[0,0,1] op_sel_hi:[1,0,1]
    v_pk_fma_f32 v[142:143], v[106:107], v[82:83], v[82:83] op_sel:[0,0,1] op_sel_hi:[1,0,1]
    v_pk_fma_f32 v[144:145], v[108:109], v[82:83], v[82:83] op_sel:[0,0,1] op_sel_hi:[1,0,1]
    v_cvt_pk_bf16_f32 v122, v130, v131
    v_cvt_pk_bf16_f32 v123, v132, v133
    v_cvt_pk_bf16_f32 v124, v134, v135
    v_cvt_pk_bf16_f32 v125, v136, v137
    v_cvt_pk_bf16_f32 v126, v138, v139
    v_cvt_pk_bf16_f32 v127, v140, v141
    v_cvt_pk_bf16_f32 v128, v142, v143
    v_cvt_pk_bf16_f32 v129, v144, v145
    v_cndmask_b32 v9, v47, v8, vcc
    v_cmp_ge_u32 vcc, v85, v87
    v_lshrrev_b32 v6, 3, v2
    s_mov_b64 exec, vcc
    buffer_store_dwordx4 v[122:125], v7, s[12:15], s60 offen sc1
    buffer_store_dwordx4 v[126:129], v7, s[12:15], s60 offen offset:64 sc1
    ds_write_b128 v9, v[122:125] offset:128
    ds_write_b128 v9, v[126:129] offset:192
    ds_write_b128 v9, v[52:55]
    ds_write_b128 v9, v[56:59] offset:64
    s_mov_b64 exec, -1
    s_waitcnt lgkmcnt(0)
    v_lshlrev_b32 v130, 16, v122
    v_and_b32 v131, 0xffff0000, v122
    v_lshlrev_b32 v132, 16, v123
    v_and_b32 v133, 0xffff0000, v123
    v_lshlrev_b32 v134, 16, v124
    v_and_b32 v135, 0xffff0000, v124
    v_lshlrev_b32 v136, 16, v125
    v_and_b32 v137, 0xffff0000, v125
    v_lshlrev_b32 v138, 16, v126
    v_and_b32 v139, 0xffff0000, v126
    v_lshlrev_b32 v140, 16, v127
    v_and_b32 v141, 0xffff0000, v127
    v_lshlrev_b32 v142, 16, v128
    v_and_b32 v143, 0xffff0000, v128
    v_lshlrev_b32 v144, 16, v129
    v_and_b32 v145, 0xffff0000, v129
    v_pk_add_f32 v[130:131], v[130:131], v[94:95]
    v_pk_add_f32 v[132:133], v[132:133], v[96:97]
    v_pk_add_f32 v[134:135], v[134:135], v[98:99]
    v_pk_add_f32 v[136:137], v[136:137], v[100:101]
    v_pk_add_f32 v[138:139], v[138:139], v[102:103]
    v_pk_add_f32 v[140:141], v[140:141], v[104:105]
    v_pk_add_f32 v[142:143], v[142:143], v[106:107]
    v_pk_add_f32 v[144:145], v[144:145], v[108:109]
    v_cvt_pk_bf16_f32 v52, v130, v131
    v_cvt_pk_bf16_f32 v53, v132, v133
    v_cvt_pk_bf16_f32 v54, v134, v135
    v_cvt_pk_bf16_f32 v55, v136, v137
    v_cvt_pk_bf16_f32 v56, v138, v139
    v_cvt_pk_bf16_f32 v57, v140, v141
    v_cvt_pk_bf16_f32 v58, v142, v143
    v_cvt_pk_bf16_f32 v59, v144, v145
    v_bfe_u32 v6, v2, 2, 1
    v_and_b32 v7, 1, v2
    v_lshl_or_b32 v6, v6, 1, v7
    v_mul_u32_u24 v170, 576, v6
    v_lshl_add_u32 v170, v4, 4, v170
    v_add_u32 v170, 83968, v170
    s_lshl_b32 s61, s50, 3
    s_add_u32 s61, s61, 156288
    v_lshlrev_b32 v171, 5, v4
    v_lshl_add_u32 v171, v3, 1, v171
    v_add_u32 v171, s61, v171
    s_lshr_b32 s61, s50, 1
    s_lshl_b32 s61, s61, 5
    s_add_u32 s61, s61, 156288
    v_mov_b32 v172, s61
    v_lshlrev_b32 v173, 4, v0
    v_mov_b32 v174, 156480
    v_lshrrev_b32 v175, 5, v2
    v_lshl_add_u32 v175, v175, 6, v5
    v_add_u32 v175, 83968, v175
    s_cmp_eq_u32 s59, 0
    s_cbranch_scc1 L_x1
    v_mov_b32 v114, v52
    v_mov_b32 v115, v53
    v_mov_b32 v116, v54
    v_mov_b32 v117, v55
    v_mov_b32_dpp v52, v56 row_ror:8 row_mask:0xf bank_mask:0xc
    v_mov_b32_dpp v53, v57 row_ror:8 row_mask:0xf bank_mask:0xc
    v_mov_b32_dpp v54, v58 row_ror:8 row_mask:0xf bank_mask:0xc
    v_mov_b32_dpp v55, v59 row_ror:8 row_mask:0xf bank_mask:0xc
    v_mov_b32_dpp v56, v114 row_ror:8 row_mask:0xf bank_mask:0x3
    v_mov_b32_dpp v57, v115 row_ror:8 row_mask:0xf bank_mask:0x3
    v_mov_b32_dpp v58, v116 row_ror:8 row_mask:0xf bank_mask:0x3
    v_mov_b32_dpp v59, v117 row_ror:8 row_mask:0xf bank_mask:0x3
    v_and_b32 v6, 7, v3
    v_lshl_add_u32 v46, v6, 11, v19
    v_and_b32 v6, 8, v3
    v_lshl_add_u32 v46, v6, 3, v46
    s_branch L_x1e
L_x1:
    v_add_f32 v85, 1.0, v82
    v_mul_f32 v86, v84, v82
    v_fma_f32 v80, v80, v85, -v86
    v_mul_f32 v87, v85, v85
    v_mul_f32 v81, v81, v87
    v_cvt_pk_bf16_f32 v87, 0, v81
    v_add_f32 v87, 0x3727c5ac, v87
    v_cvt_pk_bf16_f32 v87, 0, v87
    v_sqrt_f32 v87, v87
    v_cvt_pk_bf16_f32 v88, 0, v80
    v_cvt_pk_bf16_f32 v87, 0, v87
    v_rcp_f32 v89, v87
    v_rcp_f32 v87, v85
    v_add_f32 v86, v86, v88
    v_mul_f32 v9, v85, v89
    v_mul_f32 v8, -v86, v87
    s_lshl_b32 s60, s50, 6
    v_add_u32 v6, s60, v15
    ds_write2_b32 v6, v8, v9 offset0:16 offset1:96
    s_cmp_eq_u32 s79, 0
    s_cbranch_scc1 L_sk_24
    s_mov_b32 s60, 0x05040100
    s_mov_b32 s61, 0x07060302
    s_waitcnt lgkmcnt(0)
    v_accvgpr_read_b32 v80, a224
    v_accvgpr_read_b32 v81, a225
    v_accvgpr_read_b32 v82, a226
    v_accvgpr_read_b32 v83, a227
    v_perm_b32 v84, v82, v80, s60
    v_perm_b32 v85, v82, v80, s61
    v_perm_b32 v86, v83, v81, s60
    v_perm_b32 v87, v83, v81, s61
    v_accvgpr_write_b32 a224, v84
    v_accvgpr_write_b32 a225, v85
    v_accvgpr_write_b32 a226, v86
    v_accvgpr_write_b32 a227, v87
    v_accvgpr_read_b32 v80, a228
    v_accvgpr_read_b32 v81, a229
    v_accvgpr_read_b32 v82, a230
    v_accvgpr_read_b32 v83, a231
    v_perm_b32 v84, v82, v80, s60
    v_perm_b32 v85, v82, v80, s61
    v_perm_b32 v86, v83, v81, s60
    v_perm_b32 v87, v83, v81, s61
    v_accvgpr_write_b32 a228, v84
    v_accvgpr_write_b32 a229, v85
    v_accvgpr_write_b32 a230, v86
    v_accvgpr_write_b32 a231, v87
    v_accvgpr_read_b32 v80, a232
    v_accvgpr_read_b32 v81, a233
    v_accvgpr_read_b32 v82, a234
    v_accvgpr_read_b32 v83, a235
    v_perm_b32 v84, v82, v80, s60
    v_perm_b32 v85, v82, v80, s61
    v_perm_b32 v86, v83, v81, s60
    v_perm_b32 v87, v83, v81, s61
    v_accvgpr_write_b32 a232, v84
    v_accvgpr_write_b32 a233, v85
    v_accvgpr_write_b32 a234, v86
    v_accvgpr_write_b32 a235, v87
    v_accvgpr_read_b32 v80, a236
    v_accvgpr_read_b32 v81, a237
    v_accvgpr_read_b32 v82, a238
    v_accvgpr_read_b32 v83, a239
    v_perm_b32 v84, v82, v80, s60
    v_perm_b32 v85, v82, v80, s61
    v_perm_b32 v86, v83, v81, s60
    v_perm_b32 v87, v83, v81, s61
    v_accvgpr_write_b32 a236, v84
    v_accvgpr_write_b32 a237, v85
    v_accvgpr_write_b32 a238, v86
    v_accvgpr_write_b32 a239, v87
    v_accvgpr_read_b32 v80, a240
    v_accvgpr_read_b32 v81, a241
    v_accvgpr_read_b32 v82, a242
    v_accvgpr_read_b32 v83, a243
    v_perm_b32 v84, v82, v80, s60
    v_perm_b32 v85, v82, v80, s61
    v_perm_b32 v86, v83, v81, s60
    v_perm_b32 v87, v83, v81, s61
    v_accvgpr_write_b32 a240, v84
    v_accvgpr_write_b32 a241, v85
    v_accvgpr_write_b32 a242, v86
    v_accvgpr_write_b32 a243, v87
    v_accvgpr_read_b32 v80, a244
    v_accvgpr_read_b32 v81, a245
    v_accvgpr_read_b32 v82, a246
    v_accvgpr_read_b32 v83, a247
    v_perm_b32 v84, v82, v80, s60
    v_perm_b32 v85, v82, v80, s61
    v_perm_b32 v86, v83, v81, s60
    v_perm_b32 v87, v83, v81, s61
    v_accvgpr_write_b32 a244, v84
    v_accvgpr_write_b32 a245, v85
    v_accvgpr_write_b32 a246, v86
    v_accvgpr_write_b32 a247, v87
    v_accvgpr_read_b32 v80, a248
    v_accvgpr_read_b32 v81, a249
    v_accvgpr_read_b32 v82, a250
    v_accvgpr_read_b32 v83, a251
    v_perm_b32 v84, v82, v80, s60
    v_perm_b32 v85, v82, v80, s61
    v_perm_b32 v86, v83, v81, s60
    v_perm_b32 v87, v83, v81, s61
    v_accvgpr_write_b32 a248, v84
    v_accvgpr_write_b32 a249, v85
    v_accvgpr_write_b32 a250, v86
    v_accvgpr_write_b32 a251, v87
    v_accvgpr_read_b32 v80, a252
    v_accvgpr_read_b32 v81, a253
    v_accvgpr_read_b32 v82, a254
    v_accvgpr_read_b32 v83, a255
    v_perm_b32 v84, v82, v80, s60
    v_perm_b32 v85, v82, v80, s61
    v_perm_b32 v86, v83, v81, s60
    v_perm_b32 v87, v83, v81, s61
    v_accvgpr_write_b32 a252, v84
    v_accvgpr_write_b32 a253, v85
    v_accvgpr_write_b32 a254, v86
    v_accvgpr_write_b32 a255, v87
L_sk_24:
    s_cmp_lg_u32 s50, 1
    s_cbranch_scc1 L_sk_25
    s_lshl_b32 s60, s51, 11
    s_add_u32 s60, s60, 6651904
    s_cmp_eq_u32 s79, 1
    s_cselect_b32 s60, s60, s39
    s_lshl_b32 s61, s79, 9
    v_mad_u32_u24 v9, v4, s61, v48
    s_mov_b32 s75, 2097152
L_poll_26:
    buffer_load_dwordx4 v[114:117], v9, s[12:15], s60 offen sc1
    s_waitcnt vmcnt(0)
    v_xor_b32 v114, s76, v114
    v_xor_b32 v115, s77, v115
    v_xor_b32 v116, s76, v116
    v_xor_b32 v117, s77, v117
    v_or_b32 v115, v115, v117
    v_lshrrev_b32 v115, 4, v115
    v_or3_b32 v114, v114, v115, v116
    v_cmp_ne_u32 vcc, 0, v114
    s_nop 0
    s_cbranch_vccz L_ok_27
    s_sub_u32 s75, s75, 1
    s_cbranch_scc0 L_poll_26
L_ok_27:
L_sk_25:
    s_mov_b32 s49, s79
    s_cmp_eq_u32 s79, 0
    s_cbranch_scc1 L_b1b
L_x1e:
    s_cmp_lg_u32 s50, 0
    s_cbranch_scc1 L_keye
    s_mov_b32 s75, 2097152
L_keyp:
    buffer_load_dwordx4 v[114:117], v5, s[12:15], s33 offen sc1
    s_waitcnt vmcnt(0)
L_keyc:
    v_max3_u32 v6, v114, v115, v116
    v_min_u32 v8, v114, v116
    v_max_u32 v6, v6, v117
    v_max_u32 v114, v114, v116
    v_cmp_eq_u32 vcc, -1, v6
    v_max3_u32 v115, v115, v117, v8
    s_cbranch_vccz L_keyk
    s_sleep 1
    s_cmp_eq_u32 s79, 1
    s_cbranch_scc1 L_keyh
    s_sleep 8
L_keyh:
    s_sub_u32 s75, s75, 1
    s_cbranch_scc0 L_keyp
L_keyk:
    v_min_u32_dpp v6, v114, v114 quad_perm:[1,0,3,2] row_mask:0xf bank_mask:0xf
    v_max_u32_dpp v7, v115, v115 quad_perm:[1,0,3,2] row_mask:0xf bank_mask:0xf
    v_max_u32_dpp v114, v114, v114 quad_perm:[1,0,3,2] row_mask:0xf bank_mask:0xf
    v_max_u32 v115, v6, v7
    s_nop 0
    v_min_u32_dpp v6, v114, v114 quad_perm:[2,3,0,1] row_mask:0xf bank_mask:0xf
    v_max_u32_dpp v7, v115, v115 quad_perm:[2,3,0,1] row_mask:0xf bank_mask:0xf
    v_max_u32_dpp v114, v114, v114 quad_perm:[2,3,0,1] row_mask:0xf bank_mask:0xf
    v_max_u32 v115, v6, v7
    s_nop 0
    v_min_u32_dpp v6, v114, v114 row_half_mirror row_mask:0xf bank_mask:0xf
    v_max_u32_dpp v7, v115, v115 row_half_mirror row_mask:0xf bank_mask:0xf
    v_max_u32_dpp v114, v114, v114 row_half_mirror row_mask:0xf bank_mask:0xf
    v_max_u32 v115, v6, v7
    s_nop 0
    v_min_u32_dpp v6, v114, v114 row_mirror row_mask:0xf bank_mask:0xf
    v_max_u32_dpp v7, v115, v115 row_mirror row_mask:0xf bank_mask:0xf
    v_max_u32_dpp v114, v114, v114 row_mirror row_mask:0xf bank_mask:0xf
    v_max_u32 v115, v6, v7
    v_readlane_b32 s80, v114, 0
    v_readlane_b32 s60, v114, 16
    v_readlane_b32 s62, v114, 32
    v_readlane_b32 s94, v114, 48
    v_readlane_b32 s81, v115, 0
    v_readlane_b32 s61, v115, 16
    v_readlane_b32 s63, v115, 32
    v_readlane_b32 s95, v115, 48
    s_max_u32 s81, s81, s61
    s_min_u32 s61, s80, s60
    s_max_u32 s80, s80, s60
    s_max_u32 s81, s81, s61
    s_max_u32 s81, s81, s63
    s_min_u32 s63, s80, s62
    s_max_u32 s80, s80, s62
    s_max_u32 s81, s81, s63
    s_max_u32 s81, s81, s95
    s_min_u32 s95, s80, s94
    s_max_u32 s80, s80, s94
    s_max_u32 s81, s81, s95
    s_and_b32 s96, s80, 0x7f0
    s_and_b32 s97, s81, 0x7f0
    s_cmp_eq_u32 s96, s97
    s_cselect_b32 s62, 8, 0
    s_lshl_b32 s96, s96, 7
    s_add_u32 s96, s96, s35
    s_or_b32 s97, s97, s62
    s_lshl_b32 s97, s97, 7
    s_add_u32 s97, s97, s35
    s_mov_b32 s49, s79
    s_cmp_lg_u32 s59, 0
    s_cbranch_scc1 L_sk_28
    s_mov_b32 s62, 0
    s_bfe_u32 s60, s80, 0x50006
    s_bitset1_b32 s62, s60
    s_add_u32 s60, s80, 8
    s_bfe_u32 s60, s60, 0x50006
    s_bitset1_b32 s62, s60
    s_bfe_u32 s60, s81, 0x50006
    s_bitset1_b32 s62, s60
    s_add_u32 s60, s81, 8
    s_bfe_u32 s60, s60, 0x50006
    s_bitset1_b32 s62, s60
    s_and_b32 s60, s54, 29
    s_lshr_b32 s62, s62, s60
    s_and_b32 s62, s62, 5
    s_cmp_eq_u32 s62, 1
    s_cselect_b32 s62, 2, 0
    s_and_b32 s60, s54, 2
    s_cmp_eq_u32 s60, s62
    s_cselect_b32 s79, s79, 0
L_sk_28:
    s_cmp_eq_u32 s79, 0
    s_cbranch_scc1 L_sk_29
    buffer_load_dwordx4 v[114:117], v5, s[12:15], s96 offen sc1
    buffer_load_dwordx4 v[118:121], v5, s[12:15], s97 offen sc1
L_sk_29:
    v_mov_b32 v8, s79
    ds_write_b32 v174, v8 offset:8
    v_mov_b32 v6, s80
    v_mov_b32 v7, s81
    ds_write2_b32 v174, v6, v7 offset0:0 offset1:1
    s_or_b32 s60, s49, s59
    s_cbranch_scc0 L_k2
L_keye:
    s_cmp_lg_u32 s59, 0
    s_cbranch_scc1 L_pre3
L_b1b:
    s_waitcnt lgkmcnt(0)
    s_barrier
    ds_read_b32 v6, v174 offset:8
    ds_read2_b32 v[80:81], v15 offset0:16 offset1:32
    ds_read2_b32 v[82:83], v15 offset0:48 offset1:64
    ds_read_b128 v[240:243], v18 offset:64
    ds_read_b128 v[244:247], v18 offset:128
    ds_read_b128 v[248:251], v18 offset:192
    ds_read_b128 v[252:255], v18 offset:256
    s_lshl_b32 s47, s92, 14
    s_add_u32 s65, s43, 4096
    s_xor_b32 s60, s50, 3
    s_lshl_b32 s60, s60, 29
    v_add_u32 v84, s60, v48
    s_lshl_b32 s64, s54, 10
    s_lshl_b32 s61, s53, 7
    s_add_u32 s64, s64, s61
    s_add_u32 s64, s64, 5832576
    s_waitcnt lgkmcnt(6)
    v_readfirstlane_b32 s60, v6
    s_nop 0
    s_and_b32 s79, s79, s60
    s_cbranch_scc0 L_noft
    buffer_load_dwordx4 a[192:195], v5, s[12:15], s43 offen offset:0 sc1
    buffer_load_dwordx4 a[196:199], v5, s[12:15], s43 offen offset:1024 sc1
    buffer_load_dwordx4 a[200:203], v5, s[12:15], s43 offen offset:2048 sc1
    buffer_load_dwordx4 a[204:207], v5, s[12:15], s43 offen offset:3072 sc1
    buffer_load_dwordx4 a[208:211], v5, s[12:15], s65 offen offset:0 sc1
    buffer_load_dwordx4 a[212:215], v5, s[12:15], s65 offen offset:1024 sc1
    buffer_load_dwordx4 a[216:219], v5, s[12:15], s65 offen offset:2048 sc1
    buffer_load_dwordx4 a[220:223], v5, s[12:15], s65 offen offset:3072 sc1
L_noft:
    s_add_u32 s46, s47, 0
    s_add_u32 m0, s87, 0
    s_nop 0
    buffer_load_dwordx4 v11, s[12:15], s46 offen sc1 lds
    s_add_u32 m0, s87, 1024
    s_nop 0
    buffer_load_dwordx4 v12, s[12:15], s46 offen sc1 lds
    s_waitcnt lgkmcnt(4)
    v_pk_mul_f32 v[200:201], v[70:71], v[80:81] op_sel:[0,0] op_sel_hi:[1,0]
    v_pk_mul_f32 v[202:203], v[72:73], v[80:81] op_sel:[0,0] op_sel_hi:[1,0]
    s_add_u32 s46, s47, 128
    s_add_u32 m0, s87, 8192
    s_nop 0
    buffer_load_dwordx4 v11, s[12:15], s46 offen sc1 lds
    v_pk_mul_f32 v[220:221], v[74:75], v[80:81] op_sel:[0,0] op_sel_hi:[1,0]
    v_pk_mul_f32 v[222:223], v[76:77], v[80:81] op_sel:[0,0] op_sel_hi:[1,0]
    v_pk_mul_f32 v[204:205], v[70:71], v[80:81] op_sel:[0,1] op_sel_hi:[1,1]
    v_pk_mul_f32 v[206:207], v[72:73], v[80:81] op_sel:[0,1] op_sel_hi:[1,1]
    s_add_u32 m0, s87, 9216
    s_nop 0
    buffer_load_dwordx4 v12, s[12:15], s46 offen sc1 lds
    v_pk_mul_f32 v[224:225], v[74:75], v[80:81] op_sel:[0,1] op_sel_hi:[1,1]
    v_pk_mul_f32 v[226:227], v[76:77], v[80:81] op_sel:[0,1] op_sel_hi:[1,1]
    v_pk_mul_f32 v[208:209], v[70:71], v[82:83] op_sel:[0,0] op_sel_hi:[1,0]
    v_pk_mul_f32 v[210:211], v[72:73], v[82:83] op_sel:[0,0] op_sel_hi:[1,0]
    v_pk_mul_f32 v[228:229], v[74:75], v[82:83] op_sel:[0,0] op_sel_hi:[1,0]
    v_pk_mul_f32 v[230:231], v[76:77], v[82:83] op_sel:[0,0] op_sel_hi:[1,0]
    v_pk_mul_f32 v[212:213], v[70:71], v[82:83] op_sel:[0,1] op_sel_hi:[1,1]
    v_pk_mul_f32 v[214:215], v[72:73], v[82:83] op_sel:[0,1] op_sel_hi:[1,1]
    v_pk_mul_f32 v[232:233], v[74:75], v[82:83] op_sel:[0,1] op_sel_hi:[1,1]
    v_pk_mul_f32 v[234:235], v[76:77], v[82:83] op_sel:[0,1] op_sel_hi:[1,1]
    s_waitcnt lgkmcnt(0)
    v_pk_mul_f32 v[240:241], v[240:241], v[78:79] op_sel_hi:[1,0]
    v_pk_mul_f32 v[242:243], v[242:243], v[78:79] op_sel_hi:[1,0]
    v_pk_mul_f32 v[244:245], v[244:245], v[78:79] op_sel_hi:[1,0]
    v_pk_mul_f32 v[246:247], v[246:247], v[78:79] op_sel_hi:[1,0]
    v_pk_mul_f32 v[248:249], v[248:249], v[78:79] op_sel_hi:[1,0]
    v_pk_mul_f32 v[250:251], v[250:251], v[78:79] op_sel_hi:[1,0]
    v_pk_mul_f32 v[252:253], v[252:253], v[78:79] op_sel_hi:[1,0]
    v_pk_mul_f32 v[254:255], v[254:255], v[78:79] op_sel_hi:[1,0]
    s_waitcnt vmcnt(4)
    s_mov_b32 exec_lo, 0
    s_mov_b32 exec_hi, 0xf0000f00
    buffer_store_dwordx4 v[110:113], v84, s[12:15], s64 offen sc1
    s_mov_b64 exec, -1
    s_cmp_eq_u32 s79, 0
    s_cbranch_scc1 L_g0
L_pre3:
    s_cmp_eq_u32 s50, 0
    s_cselect_b32 s60, s79, 0
    s_cmp_eq_u32 s60, 0
    s_cbranch_scc1 L_sk_30
    s_mov_b32 s75, 2097152
    s_cmp_eq_u32 s59, 0
    s_cbranch_scc1 L_cd_31c
L_cd_31:
    s_waitcnt vmcnt(0)
L_cd_31c:
    v_max_u32 v6, v114, v118
    ds_write_b128 v175, v[114:117]
    v_cmp_eq_u32 vcc, -1, v6
    ds_write_b128 v175, v[118:121] offset:1152
    s_waitcnt lgkmcnt(0)
    s_cbranch_vccz L_sk_30
    buffer_load_dwordx4 v[114:117], v5, s[12:15], s96 offen sc1
    buffer_load_dwordx4 v[118:121], v5, s[12:15], s97 offen sc1
    s_sub_u32 s75, s75, 1
    s_cbranch_scc0 L_cd_31
L_sk_30:
    s_waitcnt lgkmcnt(0)
    s_barrier
    s_cmp_eq_u32 s79, 0
    s_cbranch_scc1 L_noffn
    ds_read_b128 v[80:83], v170 offset:0
    ds_read_b128 v[84:87], v170 offset:64
    ds_read_b128 v[88:91], v170 offset:128
    ds_read_b128 v[92:95], v170 offset:192
    ds_read_b128 v[96:99], v170 offset:256
    ds_read_b128 v[100:103], v170 offset:320
    ds_read_b128 v[104:107], v170 offset:384
    ds_read_b128 v[108:111], v170 offset:448
    v_mov_b32 v134, 0
    v_mov_b32 v135, 0
    v_mov_b32 v136, 0
    v_mov_b32 v137, 0
    s_waitcnt lgkmcnt(7)
    v_mfma_f32_16x16x32_bf16 v[122:125], v[80:83], a[192:195], 0
    s_waitcnt lgkmcnt(6)
    v_mfma_f32_16x16x32_bf16 v[122:125], v[84:87], a[196:199], v[122:125]
    v_accvgpr_read_b32 v80, a224
    v_accvgpr_read_b32 v81, a225
    s_waitcnt lgkmcnt(5)
    v_mfma_f32_16x16x32_bf16 v[122:125], v[88:91], a[200:203], v[122:125]
    v_accvgpr_read_b32 v82, a226
    v_accvgpr_read_b32 v83, a227
    s_waitcnt lgkmcnt(4)
    v_mfma_f32_16x16x32_bf16 v[122:125], v[92:95], a[204:207], v[122:125]
    v_accvgpr_read_b32 v84, a228
    v_accvgpr_read_b32 v85, a229
    s_waitcnt lgkmcnt(3)
    v_mfma_f32_16x16x32_bf16 v[122:125], v[96:99], a[208:211], v[122:125]
    v_accvgpr_read_b32 v86, a230
    v_accvgpr_read_b32 v87, a231
    s_waitcnt lgkmcnt(2)
    v_mfma_f32_16x16x32_bf16 v[122:125], v[100:103], a[212:215], v[122:125]
    v_accvgpr_read_b32 v88, a232
    v_accvgpr_read_b32 v89, a233
    s_waitcnt lgkmcnt(1)
    v_mfma_f32_16x16x32_bf16 v[122:125], v[104:107], a[216:219], v[122:125]
    v_accvgpr_read_b32 v90, a234
    v_accvgpr_read_b32 v91, a235
    s_waitcnt lgkmcnt(0)
    v_mfma_f32_16x16x32_bf16 v[122:125], v[108:111], a[220:223], v[122:125]
    v_accvgpr_read_b32 v92, a236
    v_accvgpr_read_b32 v93, a237
    v_accvgpr_read_b32 v94, a238
    v_accvgpr_read_b32 v95, a239
    v_accvgpr_read_b32 v96, a240
    v_accvgpr_read_b32 v97, a241
    v_accvgpr_read_b32 v98, a242
    v_accvgpr_read_b32 v99, a243
    v_add_f32_dpp v6, v123, v122 row_shl:8 row_mask:0xf bank_mask:0xf
    v_cvt_pk_bf16_f32 v6, 0, v6
    v_mul_f32 v7, 0xbfb8aa3b, v6
    v_exp_f32 v7, v7
    v_mov_b32_dpp v8, v6 row_shl:4 row_mask:0xf bank_mask:0xf
    v_add_f32 v7, 1.0, v7
    v_rcp_f32 v7, v7
    s_mov_b64 exec, 0x000f000f
    v_mul_f32 v7, v6, v7
    v_cvt_pk_bf16_f32 v7, 0, v7
    v_mul_f32 v7, v8, v7
    v_cvt_pk_bf16_f32 v7, v7, v7
    ds_write_b16 v171, v7
    s_mov_b64 exec, -1
    v_accvgpr_read_b32 v100, a244
    v_accvgpr_read_b32 v101, a245
    v_accvgpr_read_b32 v102, a246
    v_accvgpr_read_b32 v103, a247
    v_accvgpr_read_b32 v104, a248
    v_accvgpr_read_b32 v105, a249
    v_accvgpr_read_b32 v106, a250
    v_accvgpr_read_b32 v107, a251
    s_waitcnt lgkmcnt(0)
    s_barrier
    ds_read_b128 v[126:129], v172
    ds_read_b128 v[130:133], v172 offset:16
    v_accvgpr_read_b32 v108, a252
    v_accvgpr_read_b32 v109, a253
    v_accvgpr_read_b32 v110, a254
    v_accvgpr_read_b32 v111, a255
    s_waitcnt lgkmcnt(1)
    v_dot2c_f32_bf16 v134, v80, v126
    v_dot2c_f32_bf16 v135, v81, v126
    v_dot2c_f32_bf16 v136, v82, v126
    v_dot2c_f32_bf16 v137, v83, v126
    v_dot2c_f32_bf16 v134, v84, v127
    v_dot2c_f32_bf16 v135, v85, v127
    v_dot2c_f32_bf16 v136, v86, v127
    v_dot2c_f32_bf16 v137, v87, v127
    v_dot2c_f32_bf16 v134, v88, v128
    v_dot2c_f32_bf16 v135, v89, v128
    v_dot2c_f32_bf16 v136, v90, v128
    v_dot2c_f32_bf16 v137, v91, v128
    v_dot2c_f32_bf16 v134, v92, v129
    v_dot2c_f32_bf16 v135, v93, v129
    v_dot2c_f32_bf16 v136, v94, v129
    v_dot2c_f32_bf16 v137, v95, v129
    s_waitcnt lgkmcnt(0)
    v_dot2c_f32_bf16 v134, v96, v130
    v_dot2c_f32_bf16 v135, v97, v130
    v_dot2c_f32_bf16 v136, v98, v130
    v_dot2c_f32_bf16 v137, v99, v130
    v_dot2c_f32_bf16 v134, v100, v131
    v_dot2c_f32_bf16 v135, v101, v131
    v_dot2c_f32_bf16 v136, v102, v131
    v_dot2c_f32_bf16 v137, v103, v131
    v_dot2c_f32_bf16 v134, v104, v132
    v_dot2c_f32_bf16 v135, v105, v132
    v_dot2c_f32_bf16 v136, v106, v132
    v_dot2c_f32_bf16 v137, v107, v132
    v_dot2c_f32_bf16 v134, v108, v133
    v_dot2c_f32_bf16 v135, v109, v133
    v_dot2c_f32_bf16 v136, v110, v133
    v_dot2c_f32_bf16 v137, v111, v133
    s_nop 2
    buffer_store_dwordx4 v[134:137], v173, s[12:15], s36 offen sc1
L_noffn:
    s_cmp_eq_u32 s59, 0
    s_cbranch_scc1 L_g0
    ds_read_b64 v[114:115], v174
    s_add_u32 s60, s45, 16384
    buffer_store_dwordx4 v[52:55], v46, s[16:19], s45 offen sc1
    buffer_store_dwordx4 v[56:59], v46, s[16:19], s60 offen sc1
    s_waitcnt lgkmcnt(0)
    v_readfirstlane_b32 s80, v114
    v_readfirstlane_b32 s81, v115
    s_bfe_u32 s60, s80, 0x50006
    s_bfe_u32 s61, s81, 0x50006
    s_cmp_eq_u32 s60, s54
    s_cselect_b32 s61, s54, s61
    s_cselect_b32 s82, 0, 1
    s_cselect_b32 s84, s80, s81
    s_cmp_eq_u32 s61, s54
    s_cselect_b32 s48, 1, 0
    s_branch L_gend
L_g0:
    s_waitcnt vmcnt(1)
    s_barrier
    ds_read_b128 v[80:83], v21 offset:0
    ds_read_b128 v[84:87], v21 offset:2048
    ds_read_b128 v[88:91], v21 offset:4096
    ds_read_b128 v[92:95], v21 offset:6144
    s_waitcnt lgkmcnt(0)
    v_mfma_f32_16x16x32_bf16 v[200:203], a[0:3], v[80:83], v[200:203]
    s_add_u32 s46, s47, 256
    s_add_u32 m0, s87, 16384
    s_nop 0
    buffer_load_dwordx4 v11, s[12:15], s46 offen sc1 lds
    v_mfma_f32_16x16x32_bf16 v[220:223], a[4:7], v[80:83], v[220:223]
    ds_read_b128 v[96:99], v22 offset:0
    v_mfma_f32_16x16x32_bf16 v[240:243], v[80:83], a[8:11], v[240:243]
    s_add_u32 m0, s87, 17408
    s_nop 0
    buffer_load_dwordx4 v12, s[12:15], s46 offen sc1 lds
    v_mfma_f32_16x16x32_bf16 v[204:207], a[0:3], v[84:87], v[204:207]
    ds_read_b128 v[100:103], v22 offset:2048
    v_mfma_f32_16x16x32_bf16 v[224:227], a[4:7], v[84:87], v[224:227]
    ds_read_b128 v[104:107], v22 offset:4096
    s_add_u32 s46, s47, 384
    s_add_u32 m0, s87, 24576
    s_nop 0
    buffer_load_dwordx4 v11, s[12:15], s46 offen sc1 lds
    v_mfma_f32_16x16x32_bf16 v[244:247], v[84:87], a[8:11], v[244:247]
    v_mfma_f32_16x16x32_bf16 v[208:211], a[0:3], v[88:91], v[208:211]
    ds_read_b128 v[108:111], v22 offset:6144
    s_add_u32 m0, s87, 25600
    s_nop 0
    buffer_load_dwordx4 v12, s[12:15], s46 offen sc1 lds
    v_mfma_f32_16x16x32_bf16 v[228:231], a[4:7], v[88:91], v[228:231]
    v_mfma_f32_16x16x32_bf16 v[248:251], v[88:91], a[8:11], v[248:251]
    s_add_u32 s46, s47, 512
    s_add_u32 m0, s87, 32768
    s_nop 0
    buffer_load_dwordx4 v11, s[12:15], s46 offen sc1 lds
    v_mfma_f32_16x16x32_bf16 v[212:215], a[0:3], v[92:95], v[212:215]
    v_mfma_f32_16x16x32_bf16 v[232:235], a[4:7], v[92:95], v[232:235]
    v_mfma_f32_16x16x32_bf16 v[252:255], v[92:95], a[8:11], v[252:255]
    s_add_u32 m0, s87, 33792
    s_nop 0
    buffer_load_dwordx4 v12, s[12:15], s46 offen sc1 lds
    s_waitcnt lgkmcnt(0)
    v_mfma_f32_16x16x32_bf16 v[200:203], a[12:15], v[96:99], v[200:203]
    v_mfma_f32_16x16x32_bf16 v[220:223], a[16:19], v[96:99], v[220:223]
    ds_read_b128 v[80:83], v21 offset:8192
    v_mfma_f32_16x16x32_bf16 v[240:243], v[96:99], a[20:23], v[240:243]
    s_add_u32 s46, s47, 640
    s_add_u32 m0, s87, 40960
    s_nop 0
    buffer_load_dwordx4 v11, s[12:15], s46 offen sc1 lds
    v_mfma_f32_16x16x32_bf16 v[204:207], a[12:15], v[100:103], v[204:207]
    ds_read_b128 v[84:87], v21 offset:10240
    v_mfma_f32_16x16x32_bf16 v[224:227], a[16:19], v[100:103], v[224:227]
    ds_read_b128 v[88:91], v21 offset:12288
    v_mfma_f32_16x16x32_bf16 v[244:247], v[100:103], a[20:23], v[244:247]
    s_add_u32 m0, s87, 41984
    s_nop 0
    buffer_load_dwordx4 v12, s[12:15], s46 offen sc1 lds
    v_mfma_f32_16x16x32_bf16 v[208:211], a[12:15], v[104:107], v[208:211]
    ds_read_b128 v[92:95], v21 offset:14336
    v_mfma_f32_16x16x32_bf16 v[228:231], a[16:19], v[104:107], v[228:231]
    v_mfma_f32_16x16x32_bf16 v[248:251], v[104:107], a[20:23], v[248:251]
    s_add_u32 s46, s47, 768
    s_add_u32 m0, s87, 49152
    s_nop 0
    buffer_load_dwordx4 v11, s[12:15], s46 offen sc1 lds
    v_mfma_f32_16x16x32_bf16 v[212:215], a[12:15], v[108:111], v[212:215]
    v_mfma_f32_16x16x32_bf16 v[232:235], a[16:19], v[108:111], v[232:235]
    v_mfma_f32_16x16x32_bf16 v[252:255], v[108:111], a[20:23], v[252:255]
    s_add_u32 m0, s87, 50176
    s_nop 0
    buffer_load_dwordx4 v12, s[12:15], s46 offen sc1 lds
    s_waitcnt lgkmcnt(0)
    v_mfma_f32_16x16x32_bf16 v[200:203], a[24:27], v[80:83], v[200:203]
    v_mfma_f32_16x16x32_bf16 v[220:223], a[28:31], v[80:83], v[220:223]
    ds_read_b128 v[96:99], v22 offset:8192
    v_mfma_f32_16x16x32_bf16 v[240:243], v[80:83], a[32:35], v[240:243]
    s_add_u32 s46, s47, 896
    s_add_u32 m0, s87, 57344
    s_nop 0
    buffer_load_dwordx4 v11, s[12:15], s46 offen sc1 lds
    v_mfma_f32_16x16x32_bf16 v[204:207], a[24:27], v[84:87], v[204:207]
    ds_read_b128 v[100:103], v22 offset:10240
    v_mfma_f32_16x16x32_bf16 v[224:227], a[28:31], v[84:87], v[224:227]
    ds_read_b128 v[104:107], v22 offset:12288
    v_mfma_f32_16x16x32_bf16 v[244:247], v[84:87], a[32:35], v[244:247]
    s_add_u32 m0, s87, 58368
    s_nop 0
    buffer_load_dwordx4 v12, s[12:15], s46 offen sc1 lds
    v_mfma_f32_16x16x32_bf16 v[208:211], a[24:27], v[88:91], v[208:211]
    ds_read_b128 v[108:111], v22 offset:14336
    v_mfma_f32_16x16x32_bf16 v[228:231], a[28:31], v[88:91], v[228:231]
    v_mfma_f32_16x16x32_bf16 v[248:251], v[88:91], a[32:35], v[248:251]
    v_mfma_f32_16x16x32_bf16 v[212:215], a[24:27], v[92:95], v[212:215]
    v_mfma_f32_16x16x32_bf16 v[232:235], a[28:31], v[92:95], v[232:235]
    v_mfma_f32_16x16x32_bf16 v[252:255], v[92:95], a[32:35], v[252:255]
    s_waitcnt lgkmcnt(0)
    v_mfma_f32_16x16x32_bf16 v[200:203], a[36:39], v[96:99], v[200:203]
    s_waitcnt vmcnt(8)
    s_barrier
    v_mfma_f32_16x16x32_bf16 v[220:223], a[40:43], v[96:99], v[220:223]
    ds_read_b128 v[80:83], v21 offset:16384
    v_mfma_f32_16x16x32_bf16 v[240:243], v[96:99], a[44:47], v[240:243]
    v_mfma_f32_16x16x32_bf16 v[204:207], a[36:39], v[100:103], v[204:207]
    ds_read_b128 v[84:87], v21 offset:18432
    v_mfma_f32_16x16x32_bf16 v[224:227], a[40:43], v[100:103], v[224:227]
    ds_read_b128 v[88:91], v21 offset:20480
    v_mfma_f32_16x16x32_bf16 v[244:247], v[100:103], a[44:47], v[244:247]
    v_mfma_f32_16x16x32_bf16 v[208:211], a[36:39], v[104:107], v[208:211]
    ds_read_b128 v[92:95], v21 offset:22528
    v_mfma_f32_16x16x32_bf16 v[228:231], a[40:43], v[104:107], v[228:231]
    v_mfma_f32_16x16x32_bf16 v[248:251], v[104:107], a[44:47], v[248:251]
    v_mfma_f32_16x16x32_bf16 v[212:215], a[36:39], v[108:111], v[212:215]
    v_mfma_f32_16x16x32_bf16 v[232:235], a[40:43], v[108:111], v[232:235]
    v_mfma_f32_16x16x32_bf16 v[252:255], v[108:111], a[44:47], v[252:255]
    s_waitcnt lgkmcnt(0)
    v_mfma_f32_16x16x32_bf16 v[200:203], a[48:51], v[80:83], v[200:203]
    v_mfma_f32_16x16x32_bf16 v[220:223], a[52:55], v[80:83], v[220:223]
    ds_read_b128 v[96:99], v22 offset:16384
    v_mfma_f32_16x16x32_bf16 v[240:243], v[80:83], a[56:59], v[240:243]
    v_mfma_f32_16x16x32_bf16 v[204:207], a[48:51], v[84:87], v[204:207]
    ds_read_b128 v[100:103], v22 offset:18432
    v_mfma_f32_16x16x32_bf16 v[224:227], a[52:55], v[84:87], v[224:227]
    ds_read_b128 v[104:107], v22 offset:20480
    v_mfma_f32_16x16x32_bf16 v[244:247], v[84:87], a[56:59], v[244:247]
    v_mfma_f32_16x16x32_bf16 v[208:211], a[48:51], v[88:91], v[208:211]
    ds_read_b128 v[108:111], v22 offset:22528
    v_mfma_f32_16x16x32_bf16 v[228:231], a[52:55], v[88:91], v[228:231]
    v_mfma_f32_16x16x32_bf16 v[248:251], v[88:91], a[56:59], v[248:251]
    v_mfma_f32_16x16x32_bf16 v[212:215], a[48:51], v[92:95], v[212:215]
    v_mfma_f32_16x16x32_bf16 v[232:235], a[52:55], v[92:95], v[232:235]
    buffer_load_dwordx4 v[114:117], v5, s[12:15], s33 offen sc1
    v_mfma_f32_16x16x32_bf16 v[252:255], v[92:95], a[56:59], v[252:255]
    s_waitcnt lgkmcnt(0)
    v_mfma_f32_16x16x32_bf16 v[200:203], a[60:63], v[96:99], v[200:203]
    v_mfma_f32_16x16x32_bf16 v[220:223], a[64:67], v[96:99], v[220:223]
    ds_read_b128 v[80:83], v21 offset:24576
    v_mfma_f32_16x16x32_bf16 v[240:243], v[96:99], a[68:71], v[240:243]
    v_mfma_f32_16x16x32_bf16 v[204:207], a[60:63], v[100:103], v[204:207]
    ds_read_b128 v[84:87], v21 offset:26624
    v_mfma_f32_16x16x32_bf16 v[224:227], a[64:67], v[100:103], v[224:227]
    ds_read_b128 v[88:91], v21 offset:28672
    v_mfma_f32_16x16x32_bf16 v[244:247], v[100:103], a[68:71], v[244:247]
    v_mfma_f32_16x16x32_bf16 v[208:211], a[60:63], v[104:107], v[208:211]
    ds_read_b128 v[92:95], v21 offset:30720
    v_mfma_f32_16x16x32_bf16 v[228:231], a[64:67], v[104:107], v[228:231]
    v_mfma_f32_16x16x32_bf16 v[248:251], v[104:107], a[68:71], v[248:251]
    v_mfma_f32_16x16x32_bf16 v[212:215], a[60:63], v[108:111], v[212:215]
    v_mfma_f32_16x16x32_bf16 v[232:235], a[64:67], v[108:111], v[232:235]
    v_mfma_f32_16x16x32_bf16 v[252:255], v[108:111], a[68:71], v[252:255]
    s_waitcnt vmcnt(0)
    s_mov_b32 s75, 2097152
    s_or_b32 s60, s49, s50
    s_cbranch_scc0 L_keyc
L_k2:
    s_waitcnt lgkmcnt(0)
    v_mfma_f32_16x16x32_bf16 v[200:203], a[72:75], v[80:83], v[200:203]
    v_mov_b32 v152, -1
    v_mov_b32 v153, -1
    v_mfma_f32_16x16x32_bf16 v[220:223], a[76:79], v[80:83], v[220:223]
    ds_read_b128 v[96:99], v22 offset:24576
    v_mov_b32 v154, -1
    v_mov_b32 v155, -1
    v_mfma_f32_16x16x32_bf16 v[240:243], v[80:83], a[80:83], v[240:243]
    v_lshrrev_b32 v156, 3, v3
    v_lshlrev_b32 v156, 10, v156
    v_mfma_f32_16x16x32_bf16 v[204:207], a[72:75], v[84:87], v[204:207]
    ds_read_b128 v[100:103], v22 offset:26624
    v_and_b32 v157, 0x70, v5
    v_add_u32 v156, v156, v157
    v_mfma_f32_16x16x32_bf16 v[224:227], a[76:79], v[84:87], v[224:227]
    ds_read_b128 v[104:107], v22 offset:28672
    s_lshl_b32 s60, s50, 11
    s_add_u32 s60, s60, s34
    v_mfma_f32_16x16x32_bf16 v[244:247], v[84:87], a[80:83], v[244:247]
    s_add_u32 s60, s60, 622592
    v_add_u32 v156, s60, v156
    v_mfma_f32_16x16x32_bf16 v[208:211], a[72:75], v[88:91], v[208:211]
    ds_read_b128 v[108:111], v22 offset:30720
    s_lshl_b32 s60, s2, 2
    s_add_u32 s60, s60, s50
    v_mfma_f32_16x16x32_bf16 v[228:231], a[76:79], v[88:91], v[228:231]
    s_mul_i32 s60, s60, 384
    s_add_u32 s60, s60, 5111296
    v_mfma_f32_16x16x32_bf16 v[248:251], v[88:91], a[80:83], v[248:251]
    v_add_u32 v157, s60, v5
    v_cmp_lt_u32 vcc, 31, v2
    v_mfma_f32_16x16x32_bf16 v[212:215], a[72:75], v[92:95], v[212:215]
    s_nop 0
    v_cndmask_b32 v156, v156, v157, vcc
    v_mfma_f32_16x16x32_bf16 v[232:235], a[76:79], v[92:95], v[232:235]
    v_mfma_f32_16x16x32_bf16 v[252:255], v[92:95], a[80:83], v[252:255]
    s_waitcnt lgkmcnt(0)
    v_mfma_f32_16x16x32_bf16 v[200:203], a[84:87], v[96:99], v[200:203]
    s_waitcnt vmcnt(0)
    s_barrier
    s_cmp_lg_u32 s50, 2
    s_cbranch_scc1 L_sk_32
    s_lshl_b32 s61, s53, 3
    s_add_u32 s61, s61, s39
    s_mov_b64 exec, 1
    s_cmp_eq_u32 s58, 0
    s_cbranch_scc1 L_rem_33
    buffer_store_dwordx2 v[44:45], v5, s[12:15], s61 offen offset:256
L_st_34:
    s_nop 0
    s_mov_b64 exec, -1
L_sk_32:
    s_mov_b32 exec_hi, 0xffffff
    s_mov_b32 exec_lo, 0xffff
    buffer_store_dwordx4 v[152:155], v156, s[12:15], 0 offen sc1
    s_mov_b64 exec, -1
    ds_read_b64 v[114:115], v174
    v_mfma_f32_16x16x32_bf16 v[220:223], a[88:91], v[96:99], v[220:223]
    ds_read_b128 v[80:83], v21 offset:32768
    s_lshl_b32 s94, s54, 10
    s_add_u32 s94, s94, 5831680
    v_mfma_f32_16x16x32_bf16 v[240:243], v[96:99], a[92:95], v[240:243]
    s_lshl_b32 s95, s54, 13
    s_lshl_b32 s60, s50, 8
    v_mfma_f32_16x16x32_bf16 v[204:207], a[84:87], v[100:103], v[204:207]
    ds_read_b128 v[84:87], v21 offset:34816
    s_add_u32 s95, s95, s60
    s_add_u32 s95, s95, 6275072
    v_mfma_f32_16x16x32_bf16 v[224:227], a[88:91], v[100:103], v[224:227]
    ds_read_b128 v[88:91], v21 offset:36864
    s_add_u32 s96, s95, 128
    s_mul_i32 s97, s50, 2560
    v_mfma_f32_16x16x32_bf16 v[244:247], v[100:103], a[92:95], v[244:247]
    s_lshl_b32 s60, s57, 30
    v_add_u32 v150, s60, v12
    v_mfma_f32_16x16x32_bf16 v[208:211], a[84:87], v[104:107], v[208:211]
    ds_read_b128 v[92:95], v21 offset:38912
    s_sub_u32 s64, s57, 1
    s_mov_b32 s65, s64
    v_mfma_f32_16x16x32_bf16 v[228:231], a[88:91], v[104:107], v[228:231]
    s_mov_b32 s75, 2097152
    v_mfma_f32_16x16x32_bf16 v[248:251], v[104:107], a[92:95], v[248:251]
    v_mfma_f32_16x16x32_bf16 v[212:215], a[84:87], v[108:111], v[212:215]
    v_mfma_f32_16x16x32_bf16 v[232:235], a[88:91], v[108:111], v[232:235]
    v_mfma_f32_16x16x32_bf16 v[252:255], v[108:111], a[92:95], v[252:255]
    s_waitcnt lgkmcnt(0)
    v_mfma_f32_16x16x32_bf16 v[200:203], a[96:99], v[80:83], v[200:203]
    v_readfirstlane_b32 s80, v114
    v_readfirstlane_b32 s81, v115
    v_mfma_f32_16x16x32_bf16 v[220:223], a[100:103], v[80:83], v[220:223]
    ds_read_b128 v[96:99], v22 offset:32768
    s_bfe_u32 s60, s80, 0x50006
    s_bfe_u32 s61, s81, 0x50006
    v_mfma_f32_16x16x32_bf16 v[240:243], v[80:83], a[104:107], v[240:243]
    s_cmp_eq_u32 s60, s54
    s_cselect_b32 s61, s54, s61
    s_cselect_b32 s82, 0, 1
    s_cselect_b32 s84, s80, s81
    s_cmp_eq_u32 s61, s54
    s_cselect_b32 s48, 1, 0
    v_mfma_f32_16x16x32_bf16 v[204:207], a[96:99], v[84:87], v[204:207]
    ds_read_b128 v[100:103], v22 offset:34816
    s_lshl_b32 s60, s82, 11
    s_add_u32 s60, s60, s37
    v_mfma_f32_16x16x32_bf16 v[224:227], a[100:103], v[84:87], v[224:227]
    ds_read_b128 v[104:107], v22 offset:36864
    v_lshrrev_b32 v6, 4, v0
    v_lshl_add_u32 v112, v6, 12, v48
    v_mfma_f32_16x16x32_bf16 v[244:247], v[84:87], a[104:107], v[244:247]
    v_cmp_gt_u32 vcc, 6, v6
    v_add_u32 v112, s60, v112
    v_mfma_f32_16x16x32_bf16 v[208:211], a[96:99], v[88:91], v[208:211]
    ds_read_b128 v[108:111], v22 offset:38912
    v_mov_b32 v7, 0x40000000
    v_cndmask_b32 v113, v7, v112, vcc
    v_mfma_f32_16x16x32_bf16 v[228:231], a[100:103], v[88:91], v[228:231]
    s_and_b32 s83, s84, 2047
    s_bfe_u32 s60, s80, 0x70004
    v_mfma_f32_16x16x32_bf16 v[248:251], v[88:91], a[104:107], v[248:251]
    s_bfe_u32 s62, s84, 0x70004
    s_cmp_eq_u32 s60, s62
    s_cselect_b32 s60, s82, 0
    v_mfma_f32_16x16x32_bf16 v[212:215], a[96:99], v[92:95], v[212:215]
    s_lshl_b32 s60, s60, 8
    s_and_b32 s62, s62, 3
    v_mfma_f32_16x16x32_bf16 v[232:235], a[100:103], v[92:95], v[232:235]
    s_lshl_b32 s62, s62, 9
    s_add_u32 s60, s60, s62
    v_mfma_f32_16x16x32_bf16 v[252:255], v[92:95], a[104:107], v[252:255]
    s_add_u32 s60, s60, 154240
    v_lshl_add_u32 v149, v2, 1, s60
    s_waitcnt lgkmcnt(0)
    v_mfma_f32_16x16x32_bf16 v[200:203], a[108:111], v[96:99], v[200:203]
    buffer_load_dwordx4 v[114:117], v5, s[12:15], s94 offen sc1
    ds_read_u16 v147, v149
    ds_read_u16 v148, v149 offset:128
    v_mfma_f32_16x16x32_bf16 v[220:223], a[112:115], v[96:99], v[220:223]
    ds_read_b128 v[80:83], v21 offset:40960
    s_ashr_i32 s62, s84, 31
    s_not_b32 s62, s62
    v_mfma_f32_16x16x32_bf16 v[240:243], v[96:99], a[116:119], v[240:243]
    s_or_b32 s62, s62, 0x80000000
    s_xor_b32 s62, s62, s84
    v_mfma_f32_16x16x32_bf16 v[204:207], a[108:111], v[100:103], v[204:207]
    ds_read_b128 v[84:87], v21 offset:43008
    v_mov_b32 v146, s62
    v_cvt_pk_bf16_f32 v146, 0, v146
    v_mfma_f32_16x16x32_bf16 v[224:227], a[112:115], v[100:103], v[224:227]
    ds_read_b128 v[88:91], v21 offset:45056
    v_mul_f32 v146, 0xbfb8aa3b, v146
    v_exp_f32 v146, v146
    v_mfma_f32_16x16x32_bf16 v[244:247], v[100:103], a[116:119], v[244:247]
    v_add_f32 v146, 1.0, v146
    v_rcp_f32 v146, v146
    v_mfma_f32_16x16x32_bf16 v[208:211], a[108:111], v[104:107], v[208:211]
    ds_read_b128 v[92:95], v21 offset:47104
    v_cvt_pk_bf16_f32 v146, 0, v146
    v_lshlrev_b32 v149, 4, v0
    v_mfma_f32_16x16x32_bf16 v[228:231], a[112:115], v[104:107], v[228:231]
    v_add_u32 v149, 75776, v149
    s_lshl_b32 s62, s53, 7
    v_mfma_f32_16x16x32_bf16 v[248:251], v[104:107], a[116:119], v[248:251]
    s_and_b32 s100, s83, 1023
    s_lshl_b32 s100, s100, 11
    v_mfma_f32_16x16x32_bf16 v[212:215], a[108:111], v[108:111], v[212:215]
    s_and_b32 s60, s83, 1024
    s_add_u32 s100, s100, s60
    v_mfma_f32_16x16x32_bf16 v[232:235], a[112:115], v[108:111], v[232:235]
    s_add_u32 s100, s100, s62
    s_lshl_b32 s101, s82, 10
    v_mfma_f32_16x16x32_bf16 v[252:255], v[108:111], a[116:119], v[252:255]
    s_add_u32 s101, s101, s62
    s_add_u32 s101, s101, 4194304
    s_waitcnt lgkmcnt(0)
    v_mfma_f32_16x16x32_bf16 v[200:203], a[120:123], v[80:83], v[200:203]
    v_lshlrev_b32 v147, 16, v147
    v_lshlrev_b32 v148, 16, v148
    v_mfma_f32_16x16x32_bf16 v[220:223], a[124:127], v[80:83], v[220:223]
    ds_read_b128 v[96:99], v22 offset:40960
    v_mfma_f32_16x16x32_bf16 v[240:243], v[80:83], a[128:131], v[240:243]
    v_mfma_f32_16x16x32_bf16 v[204:207], a[120:123], v[84:87], v[204:207]
    ds_read_b128 v[100:103], v22 offset:43008
    v_mfma_f32_16x16x32_bf16 v[224:227], a[124:127], v[84:87], v[224:227]
    ds_read_b128 v[104:107], v22 offset:45056
    v_mfma_f32_16x16x32_bf16 v[244:247], v[84:87], a[128:131], v[244:247]
    v_mfma_f32_16x16x32_bf16 v[208:211], a[120:123], v[88:91], v[208:211]
    ds_read_b128 v[108:111], v22 offset:47104
    v_mfma_f32_16x16x32_bf16 v[228:231], a[124:127], v[88:91], v[228:231]
    v_mfma_f32_16x16x32_bf16 v[248:251], v[88:91], a[128:131], v[248:251]
    v_mfma_f32_16x16x32_bf16 v[212:215], a[120:123], v[92:95], v[212:215]
    v_mfma_f32_16x16x32_bf16 v[232:235], a[124:127], v[92:95], v[232:235]
    v_mfma_f32_16x16x32_bf16 v[252:255], v[92:95], a[128:131], v[252:255]
    s_waitcnt lgkmcnt(0)
    v_mfma_f32_16x16x32_bf16 v[200:203], a[132:135], v[96:99], v[200:203]
    s_waitcnt vmcnt(0)
L_hs:
    v_cmp_ne_u32 vcc, s76, v117
    s_nop 0
    s_and_b64 vcc, vcc, s[64:65]
    s_cbranch_vccnz L_hsr
L_hsok:
    v_mfma_f32_16x16x32_bf16 v[220:223], a[136:139], v[96:99], v[220:223]
    ds_read_b128 v[80:83], v21 offset:49152
    s_add_u32 m0, s97, 65536
    s_nop 0
    buffer_load_dwordx4 v150, s[12:15], s95 offen sc1 lds
    v_mfma_f32_16x16x32_bf16 v[240:243], v[96:99], a[140:143], v[240:243]
    s_add_u32 m0, s97, 66816
    s_nop 0
    buffer_load_dwordx4 v150, s[12:15], s96 offen sc1 lds
    s_cmp_lg_u32 s48, 0
    s_cbranch_scc1 L_ys
L_ysr:
    v_add_f32_dpp v114, v114, v114 row_ror:8 row_mask:0xf bank_mask:0xf
    v_add_f32_dpp v116, v116, v116 row_ror:8 row_mask:0xf bank_mask:0xf
    v_mfma_f32_16x16x32_bf16 v[204:207], a[132:135], v[100:103], v[204:207]
    ds_read_b128 v[84:87], v21 offset:51200
    v_mov_b32 v118, v114
    v_mov_b32 v120, v116
    v_mfma_f32_16x16x32_bf16 v[224:227], a[136:139], v[100:103], v[224:227]
    ds_read_b128 v[88:91], v21 offset:53248
    v_permlane16_swap_b32 v114, v118
    v_permlane16_swap_b32 v116, v120
    v_mfma_f32_16x16x32_bf16 v[244:247], v[100:103], a[140:143], v[244:247]
    v_add_f32 v114, v114, v118
    v_add_f32 v116, v116, v120
    v_mfma_f32_16x16x32_bf16 v[208:211], a[132:135], v[104:107], v[208:211]
    ds_read_b128 v[92:95], v21 offset:55296
    v_mov_b32 v118, v114
    v_mov_b32 v120, v116
    v_mfma_f32_16x16x32_bf16 v[228:231], a[136:139], v[104:107], v[228:231]
    v_permlane32_swap_b32 v114, v118
    v_permlane32_swap_b32 v116, v120
    v_mfma_f32_16x16x32_bf16 v[248:251], v[104:107], a[140:143], v[248:251]
    v_add_f32 v114, v114, v118
    v_add_f32 v116, v116, v120
    v_mfma_f32_16x16x32_bf16 v[212:215], a[132:135], v[108:111], v[212:215]
    v_mul_f32 v150, 0x3b000000, v114
    v_mul_f32 v151, 0x3b000000, v116
    v_mfma_f32_16x16x32_bf16 v[232:235], a[136:139], v[108:111], v[232:235]
    v_fma_f32 v151, -v150, v150, v151
    v_max_f32 v151, 0, v151
    v_mfma_f32_16x16x32_bf16 v[252:255], v[108:111], a[140:143], v[252:255]
    v_cvt_pk_bf16_f32 v6, 0, v151
    v_add_f32 v6, 0x3727c5ac, v6
    s_waitcnt lgkmcnt(0)
    v_mfma_f32_16x16x32_bf16 v[200:203], a[144:147], v[80:83], v[200:203]
    v_cvt_pk_bf16_f32 v6, 0, v6
    v_sqrt_f32 v6, v6
    v_mfma_f32_16x16x32_bf16 v[220:223], a[148:151], v[80:83], v[220:223]
    ds_read_b128 v[96:99], v22 offset:49152
    v_cvt_pk_bf16_f32 v153, 0, v150
    v_cvt_pk_bf16_f32 v6, 0, v6
    v_mfma_f32_16x16x32_bf16 v[240:243], v[80:83], a[152:155], v[240:243]
    v_rcp_f32 v152, v6
    s_nop 0
    v_add_f32 v154, 1.0, v152
    v_mfma_f32_16x16x32_bf16 v[204:207], a[144:147], v[84:87], v[204:207]
    ds_read_b128 v[100:103], v22 offset:51200
    v_mul_f32 v155, v153, v152
    v_fma_f32 v150, v150, v154, -v155
    v_mfma_f32_16x16x32_bf16 v[224:227], a[148:151], v[84:87], v[224:227]
    ds_read_b128 v[104:107], v22 offset:53248
    v_mul_f32 v156, v154, v154
    v_mul_f32 v151, v151, v156
    v_mfma_f32_16x16x32_bf16 v[244:247], v[84:87], a[152:155], v[244:247]
    v_cvt_pk_bf16_f32 v156, 0, v151
    v_add_f32 v156, 0x3727c5ac, v156
    v_mfma_f32_16x16x32_bf16 v[208:211], a[144:147], v[88:91], v[208:211]
    ds_read_b128 v[108:111], v22 offset:55296
    v_cvt_pk_bf16_f32 v156, 0, v156
    v_sqrt_f32 v156, v156
    v_mfma_f32_16x16x32_bf16 v[228:231], a[148:151], v[88:91], v[228:231]
    v_cvt_pk_bf16_f32 v157, 0, v150
    v_cvt_pk_bf16_f32 v156, 0, v156
    v_mfma_f32_16x16x32_bf16 v[248:251], v[88:91], a[152:155], v[248:251]
    v_rcp_f32 v158, v156
    v_rcp_f32 v156, v154
    v_mfma_f32_16x16x32_bf16 v[212:215], a[144:147], v[92:95], v[212:215]
    v_add_f32 v155, v155, v157
    v_mul_f32 v9, v154, v158
    v_mfma_f32_16x16x32_bf16 v[232:235], a[148:151], v[92:95], v[232:235]
    v_mul_f32 v8, -v155, v156
    v_mfma_f32_16x16x32_bf16 v[252:255], v[92:95], a[152:155], v[252:255]
    s_waitcnt lgkmcnt(0)
    v_mfma_f32_16x16x32_bf16 v[200:203], a[156:159], v[96:99], v[200:203]
    v_mfma_f32_16x16x32_bf16 v[220:223], a[160:163], v[96:99], v[220:223]
    ds_read_b128 v[80:83], v21 offset:57344
    v_mfma_f32_16x16x32_bf16 v[240:243], v[96:99], a[164:167], v[240:243]
    v_mfma_f32_16x16x32_bf16 v[204:207], a[156:159], v[100:103], v[204:207]
    ds_read_b128 v[84:87], v21 offset:59392
    v_mfma_f32_16x16x32_bf16 v[224:227], a[160:163], v[100:103], v[224:227]
    ds_read_b128 v[88:91], v21 offset:61440
    v_mfma_f32_16x16x32_bf16 v[244:247], v[100:103], a[164:167], v[244:247]
    v_mfma_f32_16x16x32_bf16 v[208:211], a[156:159], v[104:107], v[208:211]
    ds_read_b128 v[92:95], v21 offset:63488
    v_mfma_f32_16x16x32_bf16 v[228:231], a[160:163], v[104:107], v[228:231]
    v_mfma_f32_16x16x32_bf16 v[248:251], v[104:107], a[164:167], v[248:251]
    v_mfma_f32_16x16x32_bf16 v[212:215], a[156:159], v[108:111], v[212:215]
    v_mfma_f32_16x16x32_bf16 v[232:235], a[160:163], v[108:111], v[232:235]
    v_mfma_f32_16x16x32_bf16 v[252:255], v[108:111], a[164:167], v[252:255]
    s_mov_b64 exec, s[64:65]
    ds_write2_b32 v15, v8, v9 offset0:0 offset1:80
    s_mov_b64 exec, -1
L_gend:
    s_cmp_eq_u32 s48, 0
    s_cbranch_scc1 L_own_end
    s_cmp_eq_u32 s59, 0
    s_cbranch_scc1 L_own2
L_own:
    s_bfe_u32 s60, s84, 0x50006
    s_cmp_lg_u32 s60, s54
    s_cbranch_scc1 L_own_end
    s_barrier
    s_lshl_b32 s60, s82, 11
    s_add_u32 s60, s60, s37
    v_lshrrev_b32 v6, 4, v0
    v_lshl_add_u32 v112, v6, 12, v48
    v_cmp_gt_u32 vcc, 6, v6
    v_add_u32 v112, s60, v112
    v_mov_b32 v7, 0x40000000
    v_cndmask_b32 v113, v7, v112, vcc
    s_mov_b32 s61, 0
    buffer_load_dwordx4 v[122:125], v112, s[12:15], s61 offen sc1
    s_mov_b32 s61, 65536
    buffer_load_dwordx4 v[126:129], v112, s[12:15], s61 offen sc1
    s_mov_b32 s61, 131072
    buffer_load_dwordx4 v[130:133], v112, s[12:15], s61 offen sc1
    s_mov_b32 s61, 196608
    buffer_load_dwordx4 v[134:137], v112, s[12:15], s61 offen sc1
    s_mov_b32 s61, 262144
    buffer_load_dwordx4 v[138:141], v112, s[12:15], s61 offen sc1
    s_mov_b32 s61, 327680
    buffer_load_dwordx4 v[142:145], v113, s[12:15], s61 offen sc1
    s_and_b32 s83, s84, 2047
    s_bfe_u32 s60, s80, 0x70004
    s_bfe_u32 s62, s84, 0x70004
    s_cmp_eq_u32 s60, s62
    s_cselect_b32 s60, s82, 0
    s_lshl_b32 s60, s60, 8
    s_and_b32 s62, s62, 3
    s_lshl_b32 s62, s62, 9
    s_add_u32 s60, s60, s62
    s_add_u32 s60, s60, 154240
    v_lshl_add_u32 v149, v2, 1, s60
    ds_read_u16 v147, v149
    ds_read_u16 v148, v149 offset:128
    s_ashr_i32 s62, s84, 31
    s_not_b32 s62, s62
    s_or_b32 s62, s62, 0x80000000
    s_xor_b32 s62, s62, s84
    v_mov_b32 v146, s62
    v_cvt_pk_bf16_f32 v146, 0, v146
    v_mul_f32 v146, 0xbfb8aa3b, v146
    v_exp_f32 v146, v146
    s_nop 0
    v_add_f32 v146, 1.0, v146
    v_rcp_f32 v146, v146
    s_nop 0
    v_cvt_pk_bf16_f32 v146, 0, v146
    s_waitcnt lgkmcnt(0)
    v_lshlrev_b32 v147, 16, v147
    v_lshlrev_b32 v148, 16, v148
    v_lshlrev_b32 v149, 4, v0
    v_add_u32 v149, 75776, v149
    s_lshl_b32 s62, s53, 7
    s_and_b32 s100, s83, 1023
    s_lshl_b32 s100, s100, 11
    s_and_b32 s60, s83, 1024
    s_add_u32 s100, s100, s60
    s_add_u32 s100, s100, s62
    s_lshl_b32 s101, s82, 10
    s_add_u32 s101, s101, s62
    s_add_u32 s101, s101, 4194304
L_own2:
    s_mov_b32 s75, 2097152
    s_mov_b32 s24, 65536
    s_mov_b32 s25, 131072
    s_mov_b32 s26, 196608
    s_mov_b32 s27, 262144
    s_mov_b32 s74, 327680
L_yp:
    s_waitcnt vmcnt(0)
    v_cmp_eq_u32 s[4:5], -1, v122
    v_cmp_eq_u32 s[6:7], -1, v126
    v_cmp_eq_u32 s[8:9], -1, v130
    v_cmp_eq_u32 s[10:11], -1, v134
    v_cmp_eq_u32 s[20:21], -1, v138
    v_cmp_eq_u32 s[22:23], -1, v142
    s_or_b64 vcc, s[4:5], s[6:7]
    s_or_b64 s[60:61], s[8:9], s[10:11]
    s_or_b64 vcc, vcc, s[20:21]
    s_or_b64 s[60:61], s[60:61], s[22:23]
    s_or_b64 vcc, vcc, s[60:61]
    s_cbranch_scc0 L_ypok
    s_mov_b64 exec, s[4:5]
    s_cbranch_execz L_yp0
    buffer_load_dwordx4 v[122:125], v112, s[12:15], 0 offen sc1
L_yp0:
    s_mov_b64 exec, s[6:7]
    s_cbranch_execz L_yp1
    buffer_load_dwordx4 v[126:129], v112, s[12:15], s24 offen sc1
L_yp1:
    s_mov_b64 exec, s[8:9]
    s_cbranch_execz L_yp2
    buffer_load_dwordx4 v[130:133], v112, s[12:15], s25 offen sc1
L_yp2:
    s_mov_b64 exec, s[10:11]
    s_cbranch_execz L_yp3
    buffer_load_dwordx4 v[134:137], v112, s[12:15], s26 offen sc1
L_yp3:
    s_mov_b64 exec, s[20:21]
    s_cbranch_execz L_yp4
    buffer_load_dwordx4 v[138:141], v112, s[12:15], s27 offen sc1
L_yp4:
    s_mov_b64 exec, s[22:23]
    s_cbranch_execz L_yp5
    buffer_load_dwordx4 v[142:145], v113, s[12:15], s74 offen sc1
L_yp5:
    s_mov_b64 exec, -1
    s_sub_u32 s75, s75, 1
    s_cbranch_scc0 L_yp
L_ypok:
    v_pk_add_f32 v[122:123], v[122:123], v[126:127]
    v_pk_add_f32 v[124:125], v[124:125], v[128:129]
    v_pk_add_f32 v[130:131], v[130:131], v[134:135]
    v_pk_add_f32 v[132:133], v[132:133], v[136:137]
    v_pk_add_f32 v[138:139], v[138:139], v[142:143]
    v_pk_add_f32 v[140:141], v[140:141], v[144:145]
    v_pk_add_f32 v[122:123], v[122:123], v[130:131]
    v_pk_add_f32 v[124:125], v[124:125], v[132:133]
    v_pk_add_f32 v[122:123], v[122:123], v[138:139]
    v_pk_add_f32 v[124:125], v[124:125], v[140:141]
    ds_write_b128 v149, v[122:125]
    v_lshlrev_b32 v6, 2, v2
    v_add_u32 v6, 75776, v6
    s_waitcnt lgkmcnt(0)
    s_barrier
    s_cmp_lg_u32 s50, 3
    s_cbranch_scc1 L_own_sync
    ds_read2st64_b32 v[122:123], v6 offset0:0 offset1:1
    ds_read2st64_b32 v[124:125], v6 offset0:2 offset1:3
    ds_read2st64_b32 v[126:127], v6 offset0:4 offset1:5
    ds_read2st64_b32 v[128:129], v6 offset0:6 offset1:7
    ds_read2st64_b32 v[130:131], v6 offset0:8 offset1:9
    ds_read2st64_b32 v[132:133], v6 offset0:10 offset1:11
    ds_read2st64_b32 v[134:135], v6 offset0:12 offset1:13
    ds_read2st64_b32 v[136:137], v6 offset0:14 offset1:15
    v_lshlrev_b32 v6, 1, v2
    s_waitcnt lgkmcnt(6)
    v_pk_add_f32 v[122:123], v[122:123], v[124:125]
    s_waitcnt lgkmcnt(4)
    v_pk_add_f32 v[126:127], v[126:127], v[128:129]
    s_waitcnt lgkmcnt(2)
    v_pk_add_f32 v[130:131], v[130:131], v[132:133]
    s_waitcnt lgkmcnt(0)
    v_pk_add_f32 v[134:135], v[134:135], v[136:137]
    v_pk_add_f32 v[122:123], v[122:123], v[126:127]
    v_pk_add_f32 v[130:131], v[130:131], v[134:135]
    v_pk_add_f32 v[122:123], v[122:123], v[130:131]
    v_add_f32 v122, v122, v123
    v_cvt_pk_bf16_f32 v122, 0, v122
    v_mul_f32 v122, v122, v146
    v_cvt_pk_bf16_f32 v122, 0, v122
    v_add_f32 v122, v122, v148
    v_cvt_pk_bf16_f32 v122, 0, v122
    v_add_f32 v122, v122, v147
    s_nop 1
    v_mov_b32_dpp v123, v122 quad_perm:[1,0,3,2] row_mask:0xf bank_mask:0xf
    v_cvt_pk_bf16_f32 v122, v122, v123
    s_mov_b32 exec_lo, 0x55555555
    s_mov_b32 exec_hi, 0x55555555
    s_cmp_eq_u32 s59, 0
    s_cbranch_scc1 L_own_x2
    buffer_store_dword v122, v6, s[16:19], s100 offen
    s_branch L_own_fin
L_own_x2:
    s_cmp_eq_u32 s58, 0
    s_cbranch_scc1 L_rem_35
    buffer_store_dword v122, v6, s[12:15], s101 offen
L_st_36:
    s_nop 0
    s_and_b32 s60, s83, 63
    s_cmp_lt_u32 s60, 56
    s_cbranch_scc1 L_own_nh
    buffer_store_dword v122, v6, s[12:15], s101 offen offset:2048 sc1
L_own_nh:
    s_lshl_b32 s60, s82, 7
    s_add_u32 s60, s60, 81920
    v_add_u32 v6, s60, v6
    ds_write_b32 v6, v122
L_own_fin:
    s_mov_b64 exec, -1
L_own_sync:
L_own_next:
    s_mov_b32 s84, s81
    s_add_u32 s82, s82, 1
    s_cmp_lt_u32 s82, 2
    s_cbranch_scc1 L_own
L_own_end:
    s_cmp_eq_u32 s59, 1
    s_cbranch_scc1 L_fin
    s_waitcnt lgkmcnt(0)
    v_mfma_f32_16x16x32_bf16 v[200:203], a[168:171], v[80:83], v[200:203]
    s_and_b32 s60, s80, 2047
    v_mfma_f32_16x16x32_bf16 v[220:223], a[172:175], v[80:83], v[220:223]
    ds_read_b128 v[96:99], v22 offset:57344
    s_lshl_b32 s61, s54, 6
    v_mfma_f32_16x16x32_bf16 v[240:243], v[80:83], a[176:179], v[240:243]
    s_sub_u32 s60, s60, s61
    v_mfma_f32_16x16x32_bf16 v[204:207], a[168:171], v[84:87], v[204:207]
    ds_read_b128 v[100:103], v22 offset:59392
    s_add_u32 s96, s60, 16
    v_mfma_f32_16x16x32_bf16 v[224:227], a[172:175], v[84:87], v[224:227]
    ds_read_b128 v[104:107], v22 offset:61440
    s_cmp_lt_u32 s96, 80
    v_mfma_f32_16x16x32_bf16 v[244:247], v[84:87], a[176:179], v[244:247]
    s_cselect_b32 s96, s96, 0
    v_mfma_f32_16x16x32_bf16 v[208:211], a[168:171], v[88:91], v[208:211]
    ds_read_b128 v[108:111], v22 offset:63488
    s_lshl_b32 s61, s57, 3
    v_mfma_f32_16x16x32_bf16 v[228:231], a[172:175], v[88:91], v[228:231]
    s_add_u32 s61, s61, 8
    v_mfma_f32_16x16x32_bf16 v[248:251], v[88:91], a[176:179], v[248:251]
    s_cmp_ge_u32 s96, s61
    v_mfma_f32_16x16x32_bf16 v[212:215], a[168:171], v[92:95], v[212:215]
    s_cselect_b32 s96, s96, 0
    v_mfma_f32_16x16x32_bf16 v[232:235], a[172:175], v[92:95], v[232:235]
    s_and_b32 s60, s81, 2047
    v_mfma_f32_16x16x32_bf16 v[252:255], v[92:95], a[176:179], v[252:255]
    s_lshl_b32 s61, s54, 6
    s_waitcnt lgkmcnt(0)
    v_mfma_f32_16x16x32_bf16 v[200:203], a[180:183], v[96:99], v[200:203]
    s_sub_u32 s60, s60, s61
    v_mfma_f32_16x16x32_bf16 v[220:223], a[184:187], v[96:99], v[220:223]
    s_add_u32 s97, s60, 16
    v_mfma_f32_16x16x32_bf16 v[240:243], v[96:99], a[188:191], v[240:243]
    s_cmp_lt_u32 s97, 80
    v_mfma_f32_16x16x32_bf16 v[204:207], a[180:183], v[100:103], v[204:207]
    s_cselect_b32 s97, s97, 0
    v_mfma_f32_16x16x32_bf16 v[224:227], a[184:187], v[100:103], v[224:227]
    s_lshl_b32 s61, s57, 3
    v_mfma_f32_16x16x32_bf16 v[244:247], v[100:103], a[188:191], v[244:247]
    s_add_u32 s61, s61, 8
    v_mfma_f32_16x16x32_bf16 v[208:211], a[180:183], v[104:107], v[208:211]
    s_cmp_ge_u32 s97, s61
    v_mfma_f32_16x16x32_bf16 v[228:231], a[184:187], v[104:107], v[228:231]
    s_cselect_b32 s97, s97, 0
    v_mfma_f32_16x16x32_bf16 v[248:251], v[104:107], a[188:191], v[248:251]
    s_cmp_eq_u32 s50, 2
    v_mfma_f32_16x16x32_bf16 v[212:215], a[180:183], v[108:111], v[212:215]
    s_cselect_b32 s64, s96, s97
    s_cselect_b32 s82, 0, 1
    s_bitcmp1_b32 s50, 0
    s_cselect_b32 s64, 0, s64
    v_mfma_f32_16x16x32_bf16 v[232:235], a[184:187], v[108:111], v[232:235]
    s_not_b32 s93, s93
    v_mov_b32 v46, 0x40000000
    v_and_b32 v171, 56, v49
    v_mfma_f32_16x16x32_bf16 v[252:255], v[108:111], a[188:191], v[252:255]
    v_lshrrev_b32 v170, 3, v2
    v_mul_u32_u24 v170, 1152, v170
    v_add_u32 v170, v170, v5
    v_add_u32 v170, 66560, v170
    s_add_u32 s28, s28, 16384
    s_add_u32 s29, s29, 16384
    s_add_u32 s32, s32, 8192
    s_add_u32 s33, s33, 8192
    s_add_u32 s34, s34, 622592
    s_add_u32 s35, s35, 622592
    s_add_u32 s36, s36, 622592
    s_add_u32 s37, s37, 622592
    s_and_b32 s9, s96, 15
    s_lshl_b32 s4, 0x00010001, s9
    s_mov_b32 s5, s4
    s_lshr_b32 s8, s96, 4
    s_lshl_b32 s6, s8, 2
    s_lshl_b32 s8, s8, 1
    s_sub_u32 s7, s8, 2
    s_min_u32 s7, s7, 7
    s_bfe_u32 s10, s9, 0x10001
    s_add_u32 s8, s8, s10
    s_and_b32 s10, s9, 12
    s_lshl_b32 s10, s10, 2
    s_lshl_b64 s[10:11], 0xffff, s10
    s_lshl_b32 s9, s9, 4
    s_lshl_b32 s9, 0xffff, s9
    s_and_b32 s25, s97, 15
    s_lshl_b32 s20, 0x00010001, s25
    s_mov_b32 s21, s20
    s_lshr_b32 s24, s97, 4
    s_lshl_b32 s22, s24, 2
    s_lshl_b32 s24, s24, 1
    s_sub_u32 s23, s24, 2
    s_min_u32 s23, s23, 7
    s_bfe_u32 s26, s25, 0x10001
    s_add_u32 s24, s24, s26
    s_and_b32 s26, s25, 12
    s_lshl_b32 s26, s26, 2
    s_lshl_b64 s[26:27], 0xffff, s26
    s_lshl_b32 s25, s25, 4
    s_lshl_b32 s25, 0xffff, s25
    buffer_load_dwordx2 v[168:169], v171, s[12:15], s39 offen offset:256 sc1
    ds_read2_b32 v[148:149], v15 offset0:96 offset1:112
    ds_read2_b32 v[150:151], v15 offset0:128 offset1:144
    ds_read_b128 v[152:155], v18 offset:384
    ds_read_b128 v[156:159], v18 offset:448
    ds_read_b128 v[160:163], v18 offset:512
    ds_read_b128 v[164:167], v18 offset:576
    s_cmp_eq_u32 s64, 0
    s_cbranch_scc1 L_sk_37
    s_cmp_lt_u32 s64, 16
    s_cselect_b32 s61, 2, 0
    s_add_u32 s60, s82, s61
    s_lshl_b32 s60, s60, 10
    s_add_u32 s60, s60, 4194304
    buffer_load_dwordx4 v[144:147], v5, s[12:15], s60 offen sc1
    s_lshl_b32 s61, s82, 7
    v_add_u32 v8, s61, v170
    s_mov_b32 s75, 2097152
L_rp_38:
    s_waitcnt vmcnt(0)
    v_max3_u32 v6, v144, v145, v146
    ds_write_b128 v8, v[144:147]
    v_max_u32 v6, v6, v147
    v_cmp_eq_u32 vcc, -1, v6
    s_waitcnt lgkmcnt(0)
    s_cbranch_vccz L_ok_39
    buffer_load_dwordx4 v[144:147], v5, s[12:15], s60 offen sc1
    s_sub_u32 s75, s75, 1
    s_cbranch_scc0 L_rp_38
L_ok_39:
L_sk_37:
    s_waitcnt vmcnt(0) lgkmcnt(0)
    s_barrier
    s_or_b32 s60, s96, s97
    s_cbranch_scc0 L_nofix
    ds_read_b128 v[136:139], v170 offset:0
    ds_read_b128 v[140:143], v170 offset:128
    ds_read_b128 v[80:83], v23 offset:0
    ds_read_b128 v[84:87], v24 offset:0
    ds_read_b128 v[88:91], v23 offset:1280
    ds_read_b128 v[92:95], v24 offset:1280
    ds_read_b128 v[96:99], v23 offset:2560
    ds_read_b128 v[100:103], v24 offset:2560
    ds_read_b128 v[104:107], v23 offset:3840
    ds_read_b128 v[108:111], v24 offset:3840
    ds_read_b128 v[112:115], v23 offset:5120
    ds_read_b128 v[116:119], v24 offset:5120
    v_mov_b32 v172, 0
    v_mov_b32 v173, 0
    v_mov_b32 v174, 0
    v_mov_b32 v175, 0
    s_waitcnt lgkmcnt(10)
    v_dot2c_f32_bf16 v172, v136, v16
    v_dot2c_f32_bf16 v173, v136, v136
    v_dot2c_f32_bf16 v174, v140, v16
    v_dot2c_f32_bf16 v175, v140, v140
    v_dot2c_f32_bf16 v172, v137, v16
    v_dot2c_f32_bf16 v173, v137, v137
    v_dot2c_f32_bf16 v174, v141, v16
    v_dot2c_f32_bf16 v175, v141, v141
    v_dot2c_f32_bf16 v172, v138, v16
    v_dot2c_f32_bf16 v173, v138, v138
    v_dot2c_f32_bf16 v174, v142, v16
    v_dot2c_f32_bf16 v175, v142, v142
    v_dot2c_f32_bf16 v172, v139, v16
    v_dot2c_f32_bf16 v173, v139, v139
    v_dot2c_f32_bf16 v174, v143, v16
    v_dot2c_f32_bf16 v175, v143, v143
    s_waitcnt lgkmcnt(7)
    v_mfma_f32_16x16x32_bf16 v[216:219], a[4:7], v[80:83], 0
    ds_read_b128 v[120:123], v23 offset:6400
    v_mul_f32 v240, v240, v152
    v_mul_f32 v241, v241, v153
    v_mfma_f32_16x16x32_bf16 v[236:239], v[80:83], a[8:11], 0
    v_mul_f32 v242, v242, v154
    v_mul_f32 v243, v243, v155
    v_mfma_f32_16x16x32_bf16 v[196:199], a[0:3], v[80:83], 0
    v_cvt_pk_bf16_f32 v178, v240, v241
    v_cvt_pk_bf16_f32 v179, v242, v243
    v_mfma_f32_16x16x32_bf16 v[216:219], a[16:19], v[84:87], v[216:219]
    ds_read_b128 v[124:127], v24 offset:6400
    v_mul_f32 v244, v244, v156
    v_mul_f32 v245, v245, v157
    v_mfma_f32_16x16x32_bf16 v[236:239], v[84:87], a[20:23], v[236:239]
    v_mul_f32 v246, v246, v158
    v_mul_f32 v247, v247, v159
    v_mfma_f32_16x16x32_bf16 v[196:199], a[12:15], v[84:87], v[196:199]
    v_cvt_pk_bf16_f32 v180, v244, v245
    v_cvt_pk_bf16_f32 v181, v246, v247
    v_mfma_f32_16x16x32_bf16 v[216:219], a[28:31], v[88:91], v[216:219]
    ds_read_b128 v[128:131], v23 offset:7680
    v_mul_f32 v248, v248, v160
    v_mul_f32 v249, v249, v161
    v_mfma_f32_16x16x32_bf16 v[236:239], v[88:91], a[32:35], v[236:239]
    v_mul_f32 v250, v250, v162
    v_mul_f32 v251, v251, v163
    v_mfma_f32_16x16x32_bf16 v[196:199], a[24:27], v[88:91], v[196:199]
    v_cvt_pk_bf16_f32 v182, v248, v249
    v_cvt_pk_bf16_f32 v183, v250, v251
    s_waitcnt lgkmcnt(3)
    v_mfma_f32_16x16x32_bf16 v[216:219], a[40:43], v[92:95], v[216:219]
    ds_read_b128 v[132:135], v24 offset:7680
    v_mul_f32 v252, v252, v164
    v_mul_f32 v253, v253, v165
    v_mfma_f32_16x16x32_bf16 v[236:239], v[92:95], a[44:47], v[236:239]
    v_mul_f32 v254, v254, v166
    v_mul_f32 v255, v255, v167
    v_mfma_f32_16x16x32_bf16 v[196:199], a[36:39], v[92:95], v[196:199]
    v_cvt_pk_bf16_f32 v184, v252, v253
    v_cvt_pk_bf16_f32 v185, v254, v255
    v_mfma_f32_16x16x32_bf16 v[216:219], a[52:55], v[96:99], v[216:219]
    ds_read_b128 v[136:139], v23 offset:8960
    v_cvt_pk_bf16_f32 v200, v200, v201
    v_cvt_pk_bf16_f32 v201, v202, v203
    v_mfma_f32_16x16x32_bf16 v[236:239], v[96:99], a[56:59], v[236:239]
    v_mul_f32 v220, v220, v148
    v_mul_f32 v221, v221, v148
    v_mfma_f32_16x16x32_bf16 v[196:199], a[48:51], v[96:99], v[196:199]
    v_mul_f32 v222, v222, v148
    v_mul_f32 v223, v223, v148
    v_mfma_f32_16x16x32_bf16 v[216:219], a[64:67], v[100:103], v[216:219]
    ds_read_b128 v[140:143], v24 offset:8960
    v_cvt_pk_bf16_f32 v220, v220, v221
    v_cvt_pk_bf16_f32 v221, v222, v223
    v_mfma_f32_16x16x32_bf16 v[236:239], v[100:103], a[68:71], v[236:239]
    v_mul_f32 v186, 0x3eb8aa3b, v148
    v_cvt_pk_bf16_f32 v204, v204, v205
    v_mfma_f32_16x16x32_bf16 v[196:199], a[60:63], v[100:103], v[196:199]
    v_cvt_pk_bf16_f32 v205, v206, v207
    v_mul_f32 v224, v224, v149
    v_mfma_f32_16x16x32_bf16 v[216:219], a[76:79], v[104:107], v[216:219]
    v_mul_f32 v225, v225, v149
    v_mul_f32 v226, v226, v149
    v_mfma_f32_16x16x32_bf16 v[236:239], v[104:107], a[80:83], v[236:239]
    v_mul_f32 v227, v227, v149
    v_cvt_pk_bf16_f32 v224, v224, v225
    v_mfma_f32_16x16x32_bf16 v[196:199], a[72:75], v[104:107], v[196:199]
    v_cvt_pk_bf16_f32 v225, v226, v227
    v_mul_f32 v188, 0x3eb8aa3b, v149
    v_mfma_f32_16x16x32_bf16 v[216:219], a[88:91], v[108:111], v[216:219]
    v_cvt_pk_bf16_f32 v208, v208, v209
    v_cvt_pk_bf16_f32 v209, v210, v211
    v_mfma_f32_16x16x32_bf16 v[236:239], v[108:111], a[92:95], v[236:239]
    v_mul_f32 v228, v228, v150
    v_mul_f32 v229, v229, v150
    v_mfma_f32_16x16x32_bf16 v[196:199], a[84:87], v[108:111], v[196:199]
    v_mul_f32 v230, v230, v150
    v_mul_f32 v231, v231, v150
    v_mfma_f32_16x16x32_bf16 v[216:219], a[100:103], v[112:115], v[216:219]
    v_cvt_pk_bf16_f32 v228, v228, v229
    v_cvt_pk_bf16_f32 v229, v230, v231
    v_mfma_f32_16x16x32_bf16 v[236:239], v[112:115], a[104:107], v[236:239]
    v_mul_f32 v190, 0x3eb8aa3b, v150
    v_cvt_pk_bf16_f32 v212, v212, v213
    v_mfma_f32_16x16x32_bf16 v[196:199], a[96:99], v[112:115], v[196:199]
    v_cvt_pk_bf16_f32 v213, v214, v215
    v_mul_f32 v232, v232, v151
    s_waitcnt lgkmcnt(0)
    v_mfma_f32_16x16x32_bf16 v[216:219], a[112:115], v[116:119], v[216:219]
    v_mul_f32 v233, v233, v151
    v_mul_f32 v234, v234, v151
    v_mfma_f32_16x16x32_bf16 v[236:239], v[116:119], a[116:119], v[236:239]
    v_mul_f32 v235, v235, v151
    v_cvt_pk_bf16_f32 v232, v232, v233
    v_mfma_f32_16x16x32_bf16 v[196:199], a[108:111], v[116:119], v[196:199]
    v_cvt_pk_bf16_f32 v233, v234, v235
    v_mul_f32 v192, 0x3eb8aa3b, v151
    v_mfma_f32_16x16x32_bf16 v[216:219], a[124:127], v[120:123], v[216:219]
    ds_read2_b32 v[152:153], v15 offset0:0 offset1:80
    v_permlane32_swap_b32 v172, v174
    v_permlane32_swap_b32 v173, v175
    v_mfma_f32_16x16x32_bf16 v[236:239], v[120:123], a[128:131], v[236:239]
    v_add_f32 v172, v172, v174
    v_add_f32 v173, v173, v175
    v_mfma_f32_16x16x32_bf16 v[196:199], a[120:123], v[120:123], v[196:199]
    v_add_f32_dpp v172, v172, v172 row_ror:8 row_mask:0xf bank_mask:0xf
    v_add_f32_dpp v173, v173, v173 row_ror:8 row_mask:0xf bank_mask:0xf
    v_mfma_f32_16x16x32_bf16 v[216:219], a[136:139], v[124:127], v[216:219]
    ds_read_b128 v[154:157], v18
    v_add_f32_dpp v172, v172, v172 row_ror:4 row_mask:0xf bank_mask:0xf
    v_add_f32_dpp v173, v173, v173 row_ror:4 row_mask:0xf bank_mask:0xf
    v_mfma_f32_16x16x32_bf16 v[236:239], v[124:127], a[140:143], v[236:239]
    v_add_f32_dpp v172, v172, v172 row_ror:2 row_mask:0xf bank_mask:0xf
    v_add_f32_dpp v173, v173, v173 row_ror:2 row_mask:0xf bank_mask:0xf
    v_mfma_f32_16x16x32_bf16 v[196:199], a[132:135], v[124:127], v[196:199]
    v_add_f32_dpp v172, v172, v172 row_ror:1 row_mask:0xf bank_mask:0xf
    v_add_f32_dpp v173, v173, v173 row_ror:1 row_mask:0xf bank_mask:0xf
    v_mfma_f32_16x16x32_bf16 v[216:219], a[148:151], v[128:131], v[216:219]
    ds_read_b128 v[158:161], v18 offset:320
    v_mov_b32 v174, v172
    v_mov_b32 v175, v173
    v_mfma_f32_16x16x32_bf16 v[236:239], v[128:131], a[152:155], v[236:239]
    v_permlane16_swap_b32 v172, v174
    v_permlane16_swap_b32 v173, v175
    v_mfma_f32_16x16x32_bf16 v[196:199], a[144:147], v[128:131], v[196:199]
    v_add_f32 v172, v172, v174
    v_add_f32 v173, v173, v175
    v_mfma_f32_16x16x32_bf16 v[216:219], a[160:163], v[132:135], v[216:219]
    v_mul_f32 v144, 0x3b000000, v172
    v_mul_f32 v145, 0x3b000000, v173
    v_mfma_f32_16x16x32_bf16 v[236:239], v[132:135], a[164:167], v[236:239]
    v_fma_f32 v145, -v144, v144, v145
    v_max_f32 v145, 0, v145
    v_mfma_f32_16x16x32_bf16 v[196:199], a[156:159], v[132:135], v[196:199]
    v_cvt_pk_bf16_f32 v6, 0, v145
    v_add_f32 v6, 0x3727c5ac, v6
    v_mfma_f32_16x16x32_bf16 v[216:219], a[172:175], v[136:139], v[216:219]
    v_cvt_pk_bf16_f32 v6, 0, v6
    v_sqrt_f32 v6, v6
    v_mfma_f32_16x16x32_bf16 v[236:239], v[136:139], a[176:179], v[236:239]
    v_cvt_pk_bf16_f32 v252, 0, v144
    v_cvt_pk_bf16_f32 v6, 0, v6
    v_mfma_f32_16x16x32_bf16 v[196:199], a[168:171], v[136:139], v[196:199]
    v_rcp_f32 v253, v6
    v_xor_b32 v252, 0x80000000, v252
    v_mfma_f32_16x16x32_bf16 v[216:219], a[184:187], v[140:143], v[216:219]
    v_mov_b32 v255, v253
    v_mov_b32 v254, v252
    v_mfma_f32_16x16x32_bf16 v[236:239], v[140:143], a[188:191], v[236:239]
    s_nop 0
    v_permlane32_swap_b32 v252, v254
    v_permlane32_swap_b32 v253, v255
    v_mfma_f32_16x16x32_bf16 v[196:199], a[180:183], v[140:143], v[196:199]
    s_waitcnt lgkmcnt(0)
    v_xor_b32 v169, s77, v169
    v_xor_b32 v168, s76, v168
    v_lshrrev_b32 v169, 4, v169
    v_or_b32 v168, v168, v169
    v_cmp_ne_u32 vcc, 0, v168
    v_mov_b32_dpp v84, v216 row_newbcast:0 row_mask:0xf bank_mask:0xf
    v_mov_b32_dpp v85, v217 row_newbcast:0 row_mask:0xf bank_mask:0xf
    v_mov_b32_dpp v86, v218 row_newbcast:0 row_mask:0xf bank_mask:0xf
    v_mov_b32_dpp v87, v219 row_newbcast:0 row_mask:0xf bank_mask:0xf
    v_mov_b32 v88, v236
    v_mov_b32 v89, v236
    v_mov_b32_dpp v94, v216 row_newbcast:1 row_mask:0xf bank_mask:0xf
    v_mov_b32_dpp v95, v217 row_newbcast:1 row_mask:0xf bank_mask:0xf
    v_mov_b32_dpp v96, v218 row_newbcast:1 row_mask:0xf bank_mask:0xf
    v_mov_b32_dpp v97, v219 row_newbcast:1 row_mask:0xf bank_mask:0xf
    v_mov_b32 v98, v237
    v_mov_b32 v99, v237
    v_pk_fma_f32 v[216:217], v[74:75], v[152:153], v[216:217] op_sel_hi:[1,0,1]
    v_pk_fma_f32 v[236:237], v[154:155], v[78:79], v[236:237] op_sel_hi:[1,0,1]
    v_pk_fma_f32 v[218:219], v[76:77], v[152:153], v[218:219] op_sel_hi:[1,0,1]
    v_pk_fma_f32 v[238:239], v[156:157], v[78:79], v[238:239] op_sel_hi:[1,0,1]
    v_pk_mul_f32 v[216:217], v[216:217], v[152:153] op_sel:[0,1] op_sel_hi:[1,1]
    v_pk_mul_f32 v[236:237], v[236:237], v[158:159]
    v_pk_mul_f32 v[218:219], v[218:219], v[152:153] op_sel:[0,1] op_sel_hi:[1,1]
    v_pk_mul_f32 v[238:239], v[238:239], v[160:161]
    v_permlane32_swap_b32 v88, v89
    v_permlane32_swap_b32 v98, v99
    v_cvt_pk_bf16_f32 v216, v216, v217
    v_cvt_pk_bf16_f32 v217, v218, v219
    v_cvt_pk_bf16_f32 v176, v236, v237
    v_cvt_pk_bf16_f32 v177, v238, v239
    s_cmp_eq_u32 s96, 0
    s_cbranch_scc1 L_sk_40
    v_mov_b32_dpp v80, v196 row_newbcast:0 row_mask:0xf bank_mask:0xf
    v_mov_b32_dpp v81, v197 row_newbcast:0 row_mask:0xf bank_mask:0xf
    v_mov_b32_dpp v82, v198 row_newbcast:0 row_mask:0xf bank_mask:0xf
    v_mov_b32_dpp v83, v199 row_newbcast:0 row_mask:0xf bank_mask:0xf
    v_pk_fma_f32 v[84:85], v[74:75], v[252:253], v[84:85] op_sel_hi:[1,0,1]
    v_pk_fma_f32 v[80:81], v[70:71], v[252:253], v[80:81] op_sel_hi:[1,0,1]
    v_pk_fma_f32 v[86:87], v[76:77], v[252:253], v[86:87] op_sel_hi:[1,0,1]
    v_pk_fma_f32 v[82:83], v[72:73], v[252:253], v[82:83] op_sel_hi:[1,0,1]
    v_fma_f32 v88, v78, v252, v88
    v_pk_mul_f32 v[84:85], v[84:85], v[252:253] op_sel:[0,1] op_sel_hi:[1,1]
    v_pk_mul_f32 v[86:87], v[86:87], v[252:253] op_sel:[0,1] op_sel_hi:[1,1]
    v_mul_f32 v88, v88, v253
    v_cvt_pk_bf16_f32 v80, v80, v81
    v_cvt_pk_bf16_f32 v81, v82, v83
    v_cvt_pk_bf16_f32 v84, v84, v85
    v_cvt_pk_bf16_f32 v85, v86, v87
    v_cvt_pk_bf16_f32 v88, v88, v88
    v_mul_f32 v89, 0x3eb8aa3b, v253
    s_mov_b64 exec, s[4:5]
    s_lshr_b32 s60, s96, 4
    s_sub_u32 s60, s60, 1
    s_cmp_lg_u32 s60, s50
    s_cbranch_scc1 L_np0
    v_add_u32 v6, 81920, v19
    ds_read_b128 v[52:55], v6
    ds_read_b128 v[56:59], v6 offset:64
L_np0:
    s_set_gpr_idx_on s6, gpr_idx(SRC2,DST)
    s_nop 0
    v_mov_b32 v196, v80
    v_mov_b32 v197, v81
    v_mov_b32 v216, v84
    v_mov_b32 v217, v85
    s_set_gpr_idx_idx s7
    s_nop 0
    v_mov_b32 v186, v89
    s_set_gpr_idx_idx s8
    s_mov_b64 exec, s[10:11]
    v_bfi_b32 v176, s9, v88, v176
    s_set_gpr_idx_off
    s_mov_b64 exec, -1
L_sk_40:
    s_cmp_eq_u32 s97, 0
    s_cbranch_scc1 L_sk_41
    v_mov_b32_dpp v90, v196 row_newbcast:1 row_mask:0xf bank_mask:0xf
    v_mov_b32_dpp v91, v197 row_newbcast:1 row_mask:0xf bank_mask:0xf
    v_mov_b32_dpp v92, v198 row_newbcast:1 row_mask:0xf bank_mask:0xf
    v_mov_b32_dpp v93, v199 row_newbcast:1 row_mask:0xf bank_mask:0xf
    v_pk_fma_f32 v[94:95], v[74:75], v[254:255], v[94:95] op_sel_hi:[1,0,1]
    v_pk_fma_f32 v[90:91], v[70:71], v[254:255], v[90:91] op_sel_hi:[1,0,1]
    v_pk_fma_f32 v[96:97], v[76:77], v[254:255], v[96:97] op_sel_hi:[1,0,1]
    v_pk_fma_f32 v[92:93], v[72:73], v[254:255], v[92:93] op_sel_hi:[1,0,1]
    v_fma_f32 v98, v78, v254, v98
    v_pk_mul_f32 v[94:95], v[94:95], v[254:255] op_sel:[0,1] op_sel_hi:[1,1]
    v_pk_mul_f32 v[96:97], v[96:97], v[254:255] op_sel:[0,1] op_sel_hi:[1,1]
    v_mul_f32 v98, v98, v255
    v_cvt_pk_bf16_f32 v90, v90, v91
    v_cvt_pk_bf16_f32 v91, v92, v93
    v_cvt_pk_bf16_f32 v94, v94, v95
    v_cvt_pk_bf16_f32 v95, v96, v97
    v_cvt_pk_bf16_f32 v98, v98, v98
    v_mul_f32 v99, 0x3eb8aa3b, v255
    s_mov_b64 exec, s[20:21]
    s_lshr_b32 s60, s97, 4
    s_sub_u32 s60, s60, 1
    s_cmp_lg_u32 s60, s50
    s_cbranch_scc1 L_np1
    v_add_u32 v6, 82048, v19
    ds_read_b128 v[52:55], v6
    ds_read_b128 v[56:59], v6 offset:64
L_np1:
    s_set_gpr_idx_on s22, gpr_idx(SRC2,DST)
    s_nop 0
    v_mov_b32 v196, v90
    v_mov_b32 v197, v91
    v_mov_b32 v216, v94
    v_mov_b32 v217, v95
    s_set_gpr_idx_idx s23
    s_nop 0
    v_mov_b32 v186, v99
    s_set_gpr_idx_idx s24
    s_mov_b64 exec, s[26:27]
    v_bfi_b32 v176, s25, v98, v176
    s_set_gpr_idx_off
    s_mov_b64 exec, -1
L_sk_41:
    s_branch L_fixed
L_nofix:
    ds_read_b128 v[80:83], v23 offset:0
    ds_read_b128 v[84:87], v24 offset:0
    ds_read_b128 v[88:91], v23 offset:1280
    ds_read_b128 v[92:95], v24 offset:1280
    ds_read_b128 v[96:99], v23 offset:2560
    ds_read_b128 v[100:103], v24 offset:2560
    ds_read_b128 v[104:107], v23 offset:3840
    ds_read_b128 v[108:111], v24 offset:3840
    ds_read_b128 v[112:115], v23 offset:5120
    ds_read_b128 v[116:119], v24 offset:5120
    v_mul_f32 v240, v240, v152
    v_mul_f32 v241, v241, v153
    v_mul_f32 v242, v242, v154
    v_mul_f32 v243, v243, v155
    v_cvt_pk_bf16_f32 v178, v240, v241
    v_cvt_pk_bf16_f32 v179, v242, v243
    s_waitcnt lgkmcnt(7)
    v_mfma_f32_16x16x32_bf16 v[216:219], a[4:7], v[80:83], 0
    ds_read_b128 v[120:123], v23 offset:6400
    v_mul_f32 v244, v244, v156
    v_mul_f32 v245, v245, v157
    v_mfma_f32_16x16x32_bf16 v[236:239], v[80:83], a[8:11], 0
    v_mul_f32 v246, v246, v158
    v_mul_f32 v247, v247, v159
    v_mfma_f32_16x16x32_bf16 v[216:219], a[16:19], v[84:87], v[216:219]
    ds_read_b128 v[124:127], v24 offset:6400
    v_cvt_pk_bf16_f32 v180, v244, v245
    v_cvt_pk_bf16_f32 v181, v246, v247
    v_mfma_f32_16x16x32_bf16 v[236:239], v[84:87], a[20:23], v[236:239]
    v_mul_f32 v248, v248, v160
    v_mul_f32 v249, v249, v161
    v_mfma_f32_16x16x32_bf16 v[216:219], a[28:31], v[88:91], v[216:219]
    ds_read_b128 v[128:131], v23 offset:7680
    v_mul_f32 v250, v250, v162
    v_mul_f32 v251, v251, v163
    v_mfma_f32_16x16x32_bf16 v[236:239], v[88:91], a[32:35], v[236:239]
    v_cvt_pk_bf16_f32 v182, v248, v249
    v_cvt_pk_bf16_f32 v183, v250, v251
    s_waitcnt lgkmcnt(3)
    v_mfma_f32_16x16x32_bf16 v[216:219], a[40:43], v[92:95], v[216:219]
    ds_read_b128 v[132:135], v24 offset:7680
    v_mul_f32 v252, v252, v164
    v_mul_f32 v253, v253, v165
    v_mfma_f32_16x16x32_bf16 v[236:239], v[92:95], a[44:47], v[236:239]
    v_mul_f32 v254, v254, v166
    v_mul_f32 v255, v255, v167
    v_mfma_f32_16x16x32_bf16 v[216:219], a[52:55], v[96:99], v[216:219]
    ds_read_b128 v[136:139], v23 offset:8960
    v_cvt_pk_bf16_f32 v184, v252, v253
    v_cvt_pk_bf16_f32 v185, v254, v255
    v_mfma_f32_16x16x32_bf16 v[236:239], v[96:99], a[56:59], v[236:239]
    v_cvt_pk_bf16_f32 v200, v200, v201
    v_cvt_pk_bf16_f32 v201, v202, v203
    v_mfma_f32_16x16x32_bf16 v[216:219], a[64:67], v[100:103], v[216:219]
    ds_read_b128 v[140:143], v24 offset:8960
    v_mul_f32 v220, v220, v148
    v_mul_f32 v221, v221, v148
    v_mfma_f32_16x16x32_bf16 v[236:239], v[100:103], a[68:71], v[236:239]
    v_mul_f32 v222, v222, v148
    v_mul_f32 v223, v223, v148
    v_mfma_f32_16x16x32_bf16 v[216:219], a[76:79], v[104:107], v[216:219]
    v_cvt_pk_bf16_f32 v220, v220, v221
    v_cvt_pk_bf16_f32 v221, v222, v223
    v_mfma_f32_16x16x32_bf16 v[236:239], v[104:107], a[80:83], v[236:239]
    v_mul_f32 v186, 0x3eb8aa3b, v148
    v_cvt_pk_bf16_f32 v204, v204, v205
    v_mfma_f32_16x16x32_bf16 v[216:219], a[88:91], v[108:111], v[216:219]
    v_cvt_pk_bf16_f32 v205, v206, v207
    v_mul_f32 v224, v224, v149
    v_mfma_f32_16x16x32_bf16 v[236:239], v[108:111], a[92:95], v[236:239]
    v_mul_f32 v225, v225, v149
    v_mul_f32 v226, v226, v149
    v_mfma_f32_16x16x32_bf16 v[216:219], a[100:103], v[112:115], v[216:219]
    v_mul_f32 v227, v227, v149
    v_cvt_pk_bf16_f32 v224, v224, v225
    v_mfma_f32_16x16x32_bf16 v[236:239], v[112:115], a[104:107], v[236:239]
    v_cvt_pk_bf16_f32 v225, v226, v227
    v_mul_f32 v188, 0x3eb8aa3b, v149
    s_waitcnt lgkmcnt(0)
    v_mfma_f32_16x16x32_bf16 v[216:219], a[112:115], v[116:119], v[216:219]
    v_cvt_pk_bf16_f32 v208, v208, v209
    v_cvt_pk_bf16_f32 v209, v210, v211
    v_mfma_f32_16x16x32_bf16 v[236:239], v[116:119], a[116:119], v[236:239]
    v_mul_f32 v228, v228, v150
    v_mul_f32 v229, v229, v150
    v_mfma_f32_16x16x32_bf16 v[216:219], a[124:127], v[120:123], v[216:219]
    ds_read2_b32 v[152:153], v15 offset0:0 offset1:80
    v_mul_f32 v230, v230, v150
    v_mul_f32 v231, v231, v150
    v_mfma_f32_16x16x32_bf16 v[236:239], v[120:123], a[128:131], v[236:239]
    v_cvt_pk_bf16_f32 v228, v228, v229
    v_cvt_pk_bf16_f32 v229, v230, v231
    v_mfma_f32_16x16x32_bf16 v[216:219], a[136:139], v[124:127], v[216:219]
    ds_read_b128 v[154:157], v18
    v_mul_f32 v190, 0x3eb8aa3b, v150
    v_cvt_pk_bf16_f32 v212, v212, v213
    v_mfma_f32_16x16x32_bf16 v[236:239], v[124:127], a[140:143], v[236:239]
    v_cvt_pk_bf16_f32 v213, v214, v215
    v_mul_f32 v232, v232, v151
    v_mfma_f32_16x16x32_bf16 v[216:219], a[148:151], v[128:131], v[216:219]
    ds_read_b128 v[158:161], v18 offset:320
    v_mul_f32 v233, v233, v151
    v_mul_f32 v234, v234, v151
    v_mfma_f32_16x16x32_bf16 v[236:239], v[128:131], a[152:155], v[236:239]
    v_mul_f32 v235, v235, v151
    v_cvt_pk_bf16_f32 v232, v232, v233
    v_mfma_f32_16x16x32_bf16 v[216:219], a[160:163], v[132:135], v[216:219]
    v_cvt_pk_bf16_f32 v233, v234, v235
    v_mul_f32 v192, 0x3eb8aa3b, v151
    v_mfma_f32_16x16x32_bf16 v[236:239], v[132:135], a[164:167], v[236:239]
    v_mfma_f32_16x16x32_bf16 v[216:219], a[172:175], v[136:139], v[216:219]
    v_mfma_f32_16x16x32_bf16 v[236:239], v[136:139], a[176:179], v[236:239]
    v_mfma_f32_16x16x32_bf16 v[216:219], a[184:187], v[140:143], v[216:219]
    v_mfma_f32_16x16x32_bf16 v[236:239], v[140:143], a[188:191], v[236:239]
    s_waitcnt lgkmcnt(0)
    v_xor_b32 v169, s77, v169
    v_xor_b32 v168, s76, v168
    v_lshrrev_b32 v169, 4, v169
    v_or_b32 v168, v168, v169
    v_cmp_ne_u32 vcc, 0, v168
    s_nop 0
    v_pk_fma_f32 v[216:217], v[74:75], v[152:153], v[216:217] op_sel_hi:[1,0,1]
    v_pk_fma_f32 v[236:237], v[154:155], v[78:79], v[236:237] op_sel_hi:[1,0,1]
    v_pk_fma_f32 v[218:219], v[76:77], v[152:153], v[218:219] op_sel_hi:[1,0,1]
    v_pk_fma_f32 v[238:239], v[156:157], v[78:79], v[238:239] op_sel_hi:[1,0,1]
    v_pk_mul_f32 v[216:217], v[216:217], v[152:153] op_sel:[0,1] op_sel_hi:[1,1]
    v_pk_mul_f32 v[236:237], v[236:237], v[158:159]
    v_pk_mul_f32 v[218:219], v[218:219], v[152:153] op_sel:[0,1] op_sel_hi:[1,1]
    v_pk_mul_f32 v[238:239], v[238:239], v[160:161]
    v_cvt_pk_bf16_f32 v216, v216, v217
    v_cvt_pk_bf16_f32 v217, v218, v219
    v_cvt_pk_bf16_f32 v176, v236, v237
    v_cvt_pk_bf16_f32 v177, v238, v239
L_fixed:
    s_cbranch_vccz L_dfok
    s_mov_b32 s75, 2097152
L_poll_42:
    buffer_load_dwordx2 v[168:169], v171, s[12:15], s39 offen offset:256 sc1
    s_waitcnt vmcnt(0)
    v_xor_b32 v169, s77, v169
    v_xor_b32 v168, s76, v168
    v_lshrrev_b32 v169, 4, v169
    v_or_b32 v168, v168, v169
    v_cmp_ne_u32 vcc, 0, v168
    s_nop 0
    s_cbranch_vccz L_ok_43
    s_sub_u32 s75, s75, 1
    s_cbranch_scc0 L_poll_42
L_ok_43:
L_dfok:
    s_mov_b32 s59, 1
    v_mfma_f32_16x16x16_bf16 v[92:95], v[220:221], v[204:205], v[30:33]
    v_mfma_f32_16x16x16_bf16 v[108:111], v[224:225], v[204:205], v[34:37]
    v_mfma_f32_16x16x16_bf16 v[96:99], v[224:225], v[208:209], v[30:33]
    v_mfma_f32_16x16x16_bf16 v[112:115], v[228:229], v[208:209], v[34:37]
    v_mfma_f32_16x16x16_bf16 v[100:103], v[228:229], v[212:213], v[30:33]
    v_mfma_f32_16x16x16_bf16 v[116:119], v[232:233], v[212:213], v[34:37]
    v_mfma_f32_16x16x16_bf16 v[88:91], v[216:217], v[200:201], v[38:41]
    v_mfma_f32_16x16x16_bf16 v[104:107], v[220:221], v[200:201], v[34:37]
    s_nop 1
    v_max_f32 v108, v92, v108
    v_max_f32 v109, v93, v109
    v_max_f32 v110, v94, v110
    v_max_f32 v111, v95, v111
    v_max3_f32 v121, v108, v109, v110
    v_max_f32 v121, v121, v111
    v_max_f32 v112, v96, v112
    v_max_f32 v113, v97, v113
    v_max_f32 v114, v98, v114
    v_max_f32 v115, v99, v115
    v_max3_f32 v122, v112, v113, v114
    v_max_f32 v122, v122, v115
    v_max_f32 v116, v100, v116
    v_max_f32 v117, v101, v117
    v_max_f32 v118, v102, v118
    v_max_f32 v119, v103, v119
    v_max3_f32 v123, v116, v117, v118
    v_max_f32 v123, v123, v119
    v_max_f32 v104, v88, v104
    v_max_f32 v105, v89, v105
    v_max_f32 v106, v90, v106
    v_max_f32 v107, v91, v107
    v_max3_f32 v120, v104, v105, v106
    v_max_f32 v120, v120, v107
    v_permlane16_swap_b32 v121, v122
    s_nop 0
    v_permlane16_swap_b32 v123, v120
    v_max_f32 v121, v121, v122
    v_max_f32 v123, v123, v120
    v_mov_b32 v122, v121
    v_mov_b32 v120, v123
    s_nop 0
    v_permlane32_swap_b32 v121, v122
    v_permlane32_swap_b32 v123, v120
    v_max_f32 v121, v121, v122
    v_max_f32 v123, v123, v120
    v_mov_b32 v122, v121
    v_mov_b32 v120, v123
    s_nop 0
    v_permlane16_swap_b32 v121, v122
    v_permlane16_swap_b32 v123, v120
    v_mul_f32 v187, v120, v186
    v_mul_f32 v189, v121, v188
    v_mul_f32 v191, v122, v190
    v_mul_f32 v193, v123, v192
    v_pk_fma_f32 v[104:105], v[104:105], v[186:187], v[186:187] op_sel:[0,0,1] op_sel_hi:[1,0,1] neg_lo:[0,0,1] neg_hi:[0,0,1]
    v_pk_fma_f32 v[106:107], v[106:107], v[186:187], v[186:187] op_sel:[0,0,1] op_sel_hi:[1,0,1] neg_lo:[0,0,1] neg_hi:[0,0,1]
    v_pk_fma_f32 v[108:109], v[108:109], v[188:189], v[188:189] op_sel:[0,0,1] op_sel_hi:[1,0,1] neg_lo:[0,0,1] neg_hi:[0,0,1]
    v_pk_fma_f32 v[110:111], v[110:111], v[188:189], v[188:189] op_sel:[0,0,1] op_sel_hi:[1,0,1] neg_lo:[0,0,1] neg_hi:[0,0,1]
    v_pk_fma_f32 v[112:113], v[112:113], v[190:191], v[190:191] op_sel:[0,0,1] op_sel_hi:[1,0,1] neg_lo:[0,0,1] neg_hi:[0,0,1]
    v_pk_fma_f32 v[114:115], v[114:115], v[190:191], v[190:191] op_sel:[0,0,1] op_sel_hi:[1,0,1] neg_lo:[0,0,1] neg_hi:[0,0,1]
    v_pk_fma_f32 v[116:117], v[116:117], v[192:193], v[192:193] op_sel:[0,0,1] op_sel_hi:[1,0,1] neg_lo:[0,0,1] neg_hi:[0,0,1]
    v_pk_fma_f32 v[118:119], v[118:119], v[192:193], v[192:193] op_sel:[0,0,1] op_sel_hi:[1,0,1] neg_lo:[0,0,1] neg_hi:[0,0,1]
    v_exp_f32 v104, v104
    v_exp_f32 v105, v105
    v_exp_f32 v106, v106
    v_exp_f32 v107, v107
    v_cvt_pk_bf16_f32 v124, v104, v105
    v_cvt_pk_bf16_f32 v125, v106, v107
    v_and_b32 v88, v124, v42
    v_and_b32 v89, v125, v43
    v_xor_b32 v90, v124, v88
    v_xor_b32 v91, v125, v89
    v_exp_f32 v108, v108
    v_mfma_f32_16x16x16_bf16 v[236:239], v[16:17], v[124:125], 0
    v_exp_f32 v109, v109
    v_exp_f32 v110, v110
    v_mfma_f32_16x16x32_bf16 v[104:107], v[176:179], v[88:91], 0
    v_exp_f32 v111, v111
    v_cvt_pk_bf16_f32 v126, v108, v109
    v_cvt_pk_bf16_f32 v127, v110, v111
    v_and_b32 v92, v126, v42
    v_and_b32 v93, v127, v43
    v_xor_b32 v94, v126, v92
    v_xor_b32 v95, v127, v93
    v_exp_f32 v112, v112
    v_mfma_f32_16x16x16_bf16 v[240:243], v[16:17], v[126:127], 0
    v_exp_f32 v113, v113
    v_exp_f32 v114, v114
    v_mfma_f32_16x16x32_bf16 v[108:111], v[178:181], v[92:95], 0
    v_exp_f32 v115, v115
    v_cvt_pk_bf16_f32 v128, v112, v113
    v_cvt_pk_bf16_f32 v129, v114, v115
    v_and_b32 v96, v128, v42
    v_and_b32 v97, v129, v43
    v_xor_b32 v98, v128, v96
    v_xor_b32 v99, v129, v97
    v_exp_f32 v116, v116
    v_mfma_f32_16x16x16_bf16 v[244:247], v[16:17], v[128:129], 0
    v_exp_f32 v117, v117
    v_exp_f32 v118, v118
    v_mfma_f32_16x16x32_bf16 v[112:115], v[180:183], v[96:99], 0
    v_exp_f32 v119, v119
    v_cvt_pk_bf16_f32 v130, v116, v117
    v_cvt_pk_bf16_f32 v131, v118, v119
    v_and_b32 v100, v130, v42
    v_and_b32 v101, v131, v43
    v_xor_b32 v102, v130, v100
    v_xor_b32 v103, v131, v101
    v_mfma_f32_16x16x16_bf16 v[248:251], v[16:17], v[130:131], 0
    v_rcp_f32 v236, v236
    v_mfma_f32_16x16x32_bf16 v[116:119], v[182:185], v[100:103], 0
    v_rcp_f32 v240, v240
    v_rcp_f32 v244, v244
    v_pk_mul_f32 v[104:105], v[104:105], v[236:237] op_sel_hi:[1,0]
    v_pk_mul_f32 v[106:107], v[106:107], v[236:237] op_sel_hi:[1,0]
    v_cvt_pk_bf16_f32 v80, v104, v105
    v_cvt_pk_bf16_f32 v81, v106, v107
    v_pk_mul_f32 v[108:109], v[108:109], v[240:241] op_sel_hi:[1,0]
    v_pk_mul_f32 v[110:111], v[110:111], v[240:241] op_sel_hi:[1,0]
    v_cvt_pk_bf16_f32 v82, v108, v109
    v_cvt_pk_bf16_f32 v83, v110, v111
    s_nop 0
    v_permlane16_swap_b32 v80, v82
    v_permlane16_swap_b32 v81, v83
    v_pk_mul_f32 v[112:113], v[112:113], v[244:245] op_sel_hi:[1,0]
    v_pk_mul_f32 v[114:115], v[114:115], v[244:245] op_sel_hi:[1,0]
    v_cvt_pk_bf16_f32 v84, v112, v113
    v_cvt_pk_bf16_f32 v85, v114, v115
    v_rcp_f32 v248, v248
    s_nop 0
    v_pk_mul_f32 v[116:117], v[116:117], v[248:249] op_sel_hi:[1,0]
    v_pk_mul_f32 v[118:119], v[118:119], v[248:249] op_sel_hi:[1,0]
    v_cvt_pk_bf16_f32 v86, v116, v117
    v_cvt_pk_bf16_f32 v87, v118, v119
    s_nop 0
    v_permlane16_swap_b32 v84, v86
    v_permlane16_swap_b32 v85, v87
    s_waitcnt lgkmcnt(0)
    s_branch L_pub
L_fin:
    s_or_b32 s60, s2, s50
    s_cbranch_scc1 L_fin2
    s_mov_b32 s61, 6717440
    s_mov_b64 exec, 1
    buffer_store_dword v44, v5, s[12:15], s61 offen
    s_mov_b64 exec, -1
L_fin2:
    s_endpgm
L_s0r:
    buffer_load_dwordx4 v[114:117], v101, s[12:15], 0 offen sc1
    s_waitcnt vmcnt(0)
    s_sub_u32 s75, s75, 1
    s_cbranch_scc0 L_s0
    s_branch L_s0ok
L_hsr:
    buffer_load_dwordx4 v[114:117], v5, s[12:15], s94 offen sc1
    s_waitcnt vmcnt(0)
    s_sub_u32 s75, s75, 1
    s_cbranch_scc0 L_hs
    s_branch L_hsok
L_ys:
    s_mov_b32 s60, 4194304
    v_lshlrev_b32 v6, 7, v3
    buffer_load_dword v10, v6, s[12:15], s60 offen sc1
    s_mov_b32 s61, 0
    buffer_load_dwordx4 v[122:125], v112, s[12:15], s61 offen sc1
    s_mov_b32 s61, 65536
    buffer_load_dwordx4 v[126:129], v112, s[12:15], s61 offen sc1
    s_mov_b32 s61, 131072
    buffer_load_dwordx4 v[130:133], v112, s[12:15], s61 offen sc1
    s_mov_b32 s61, 196608
    buffer_load_dwordx4 v[134:137], v112, s[12:15], s61 offen sc1
    s_mov_b32 s61, 262144
    buffer_load_dwordx4 v[138:141], v112, s[12:15], s61 offen sc1
    s_mov_b32 s61, 327680
    buffer_load_dwordx4 v[142:145], v113, s[12:15], s61 offen sc1
    s_branch L_ysr
L_opr:
    buffer_store_dwordx4 v[80:83], v20, s[12:15], 0 offen sc1
    buffer_store_dwordx4 v[84:87], v20, s[12:15], s60 offen sc1
    s_branch L_opd
L_rem_3:
    buffer_store_dwordx2 v[44:45], v5, s[12:15], s29 offen sc1
    s_branch L_st_4
L_rem_7:
    buffer_store_dwordx2 v[44:45], v5, s[12:15], s29 offen sc1
    s_branch L_st_8
L_rem_11:
    buffer_store_dwordx4 v[110:113], v48, s[12:15], s31 offen sc1
    s_branch L_st_12
L_rem_19:
    buffer_store_dwordx4 v[52:55], v46, s[12:15], s38 offen sc1
    buffer_store_dwordx4 v[56:59], v46, s[12:15], s38 offen offset:64 sc1
    s_branch L_st_20
L_rem_22:
    buffer_store_dwordx2 v[44:45], v5, s[12:15], s40 offen sc1
    s_branch L_st_23
L_rem_33:
    buffer_store_dwordx2 v[44:45], v5, s[12:15], s61 offen offset:256 sc1
    s_branch L_st_34
L_rem_35:
    buffer_store_dword v122, v6, s[12:15], s101 offen sc1
    s_branch L_st_36
L_end:
    s_endpgm

.section .rodata,"a"
.p2align 6
.amdhsa_kernel interleave_layers__sliding_local_dilated__moe_arch_mod__prompt_kernel
  .amdhsa_next_free_vgpr 512
  .amdhsa_next_free_sgpr 102
  .amdhsa_accum_offset 256
  .amdhsa_group_segment_fixed_size 0
  .amdhsa_kernarg_size 88
  .amdhsa_user_sgpr_count 2
  .amdhsa_user_sgpr_kernarg_segment_ptr 1
  .amdhsa_system_sgpr_workgroup_id_x 1
.end_amdhsa_kernel
```
